```python
import torch

def _softmax(x, axis=-1):
    return torch.softmax(x, dim=axis)
def _gelu(x):
    return torch.nn.functional.gelu(x, approximate="tanh")
def _silu(x):
    return torch.nn.functional.silu(x)
def _sigmoid(x):
    return torch.sigmoid(x)
def _layernorm(x, axis=-1, eps=1e-5):
    m = x.mean(dim=axis, keepdim=True)
    v = x.var(dim=axis, keepdim=True, unbiased=False)
    return (x - m) / torch.sqrt(v + eps)
def _scatter_add(tgt, idx, src, axis=0):
    return tgt.clone().index_add_(axis, idx, src)
def _segment_sum(src, seg, n):
    out = torch.zeros((n,) + src.shape[1:], dtype=src.dtype)
    return out.index_add_(0, seg, src)
def _pad(x, pw):
    flat = tuple(v for pair in reversed(pw) for v in pair)
    return torch.nn.functional.pad(x, flat)

kernel_name = 'recurrent_scan__ssm_conv_s4__moe_arch_mod__prompt'

def setup_inputs():

    _w = (lambda a: (lambda t: t.to(torch.bfloat16) if t.is_floating_point() else t)(torch.as_tensor(a)))
    def _A_setup():
        B, L, D, N = 1, 2048, 512, 128
        A_re = -(lambda _x: torch.exp(torch.as_tensor(_x)))((lambda *s: torch.randn(*s, dtype=torch.bfloat16) * 6.4)(D, N))
        A_im = torch.pi * (lambda *s: torch.randn(*s, dtype=torch.bfloat16) * 0.05)(D, N)
        B_re = (lambda *s: torch.randn(*s, dtype=torch.bfloat16) * 0.1)(D, N)
        B_im = (lambda *s: torch.randn(*s, dtype=torch.bfloat16) * 0.1)(D, N)
        C_re = (lambda *s: torch.randn(*s, dtype=torch.bfloat16) * 0.1)(D, N)
        C_im = (lambda *s: torch.randn(*s, dtype=torch.bfloat16) * 0.1)(D, N)
        log_dt = (lambda *s: torch.randn(*s, dtype=torch.bfloat16) * 0.05)(D) * 0.5 - 4.0
        Dskip = (lambda *s: torch.randn(*s, dtype=torch.bfloat16) * 0.05)(D)
        return {
            "u": _w((lambda *s: torch.randn(*s, dtype=torch.bfloat16) * 0.05)(B, L, D)),
            "A_re": _w(A_re),
            "A_im": _w(A_im),
            "B_re": _w(B_re),
            "B_im": _w(B_im),
            "C_re": _w(C_re),
            "C_im": _w(C_im),
            "log_dt": _w(log_dt),
            "Dskip": _w(Dskip),
        }
    _A_in = _A_setup()

    def _B_setup():
        B, S, D, F, C = 1, 2048, 512, 1376, 1
        return {
            "x": _w((lambda *s: torch.randn(*s, dtype=torch.bfloat16) * 0.05)(B, S, D)),
            "w_r": _w((lambda *s: torch.randn(*s, dtype=torch.bfloat16) * 6.4)(D)),
            "w_gate": _w((lambda *s: torch.randn(*s, dtype=torch.bfloat16) * 0.1)(D, F)),
            "w_up": _w((lambda *s: torch.randn(*s, dtype=torch.bfloat16) * 0.1)(D, F)),
            "w_down": _w((lambda *s: torch.randn(*s, dtype=torch.bfloat16) * 0.1)(F, D)),
        }
    _B_in = _B_setup()

    return {
        "A_u": _A_in["u"],
        "A_A_re": _A_in["A_re"],
        "A_A_im": _A_in["A_im"],
        "A_B_re": _A_in["B_re"],
        "A_B_im": _A_in["B_im"],
        "A_C_re": _A_in["C_re"],
        "A_C_im": _A_in["C_im"],
        "A_log_dt": _A_in["log_dt"],
        "A_Dskip": _A_in["Dskip"],
        "B_x": _B_in["x"],
        "B_w_r": _B_in["w_r"],
        "B_w_gate": _B_in["w_gate"],
        "B_w_up": _B_in["w_up"],
        "B_w_down": _B_in["w_down"],
    }

def reference(A_u, A_A_re, A_A_im, A_B_re, A_B_im, A_C_re, A_C_im, A_log_dt, A_Dskip, B_x, B_w_r, B_w_gate, B_w_up, B_w_down):
    def _A_ref(u, A_re, A_im, B_re, B_im, C_re, C_im, log_dt, Dskip):
        Bsz, L, D = u.shape
        dt = torch.exp(log_dt)[:, None]
        A = A_re + 1j * A_im
        Bc = B_re + 1j * B_im
        Cc = C_re + 1j * C_im
        logdA = dt * A
        dB = dt * Bc
        l = (lambda x, dt: x.to(dt))(torch.arange(L), A_re.dtype)
        P = torch.exp(logdA[:, :, None] * l[None, None, :])
        K = torch.einsum("dn,dnl,dn->dl", Cc, P, dB).real
        L2 = 2 * L
        Kp = _pad(K, ((0, 0), (0, L)))
        up = (lambda x, *d: x.permute(*d))(u, 0, 2, 1)
        up = _pad(up, ((0, 0), (0, 0), (0, L)))
        Kf = (lambda x, axes=(-2,-1): torch.fft.rfft2(x.float(), dim=axes))(Kp[:, None, :], axes=(-2, -1))
        Uf = (lambda x, axes=(-2,-1): torch.fft.rfft2(x.float(), dim=axes))(up[:, :, None, :], axes=(-2, -1))
        Yf = Uf * Kf[None, :, :, :]
        y = (lambda x, s, axes=(-2,-1): torch.fft.irfft2(x, s=s, dim=axes).to(torch.bfloat16))(Yf, (1, L2), axes=(-2, -1))[:, :, 0, :L]
        y = (lambda x, *d: x.permute(*d))(y, 0, 2, 1) + u * Dskip[None, None, :]
        return y

    def _B_ref(x, w_r, w_gate, w_up, w_down):
        B, S, D = x.shape
        C = 1
        r = x @ w_r
        idx = torch.argsort(-r, axis=-1)[:, :C]
        idx_e = (lambda x, n, axis: torch.repeat_interleave(x, n, dim=axis))(idx.reshape(B, C, 1), D, axis=2)
        x_sel = (lambda x, i, axis: torch.take_along_dim(x, i, dim=axis))(x, idx_e, axis=1)
        g = _silu(x_sel @ w_gate)
        u = x_sel @ w_up
        y = (g * u) @ w_down
        r_sel = _sigmoid((lambda x, i, axis: torch.take_along_dim(x, i, dim=axis))(r, idx, axis=1))
        y = y * r_sel.reshape(B, C, 1)
        b_off = (torch.arange(B) * S).reshape(B, 1)
        flat_idx = (idx + b_off).reshape(B * C)
        zero = (x * 0.0).reshape(B * S, D)
        upd = _scatter_add(zero, flat_idx, y.reshape(B * C, D), axis=0)
        return x + upd.reshape(B, S, D)

    x = A_u
    xn = _layernorm(x, axis=-1)
    s = _A_ref(xn, A_A_re, A_A_im, A_B_re, A_B_im, A_C_re, A_C_im, A_log_dt, A_Dskip)
    g = _silu(_B_ref(xn, B_w_r, B_w_gate, B_w_up, B_w_down))
    return x + s * g
```

```asm
; @launch grid=(256,1,1) block=(576,1,1) lds=162496
.amdgcn_target "amdgcn-amd-amdhsa--gfx950"
.text
.globl recurrent_scan__ssm_conv_s4__moe_arch_mod__prompt_kernel
.p2align 8
.type recurrent_scan__ssm_conv_s4__moe_arch_mod__prompt_kernel,@function
recurrent_scan__ssm_conv_s4__moe_arch_mod__prompt_kernel:
    s_cmp_ge_u32 s2, 256
    s_cbranch_scc1 L_end
    s_load_dwordx16 s[4:19], s[0:1], 0
    s_load_dwordx16 s[20:35], s[0:1], 64
    s_load_dwordx2 s[36:37], s[0:1], 128
    v_lshrrev_b32 v1, 6, v0
    v_and_b32 v0, 63, v0
    s_and_b32 s41, s2, 7
    v_readfirstlane_b32 s40, v1
    s_lshr_b32 s42, s2, 3
    s_lshr_b32 s43, s2, 4
    s_lshl_b32 s45, s41, 4
    s_add_u32 s43, s43, s45
    s_cmp_eq_u32 s40, 0
    s_cbranch_scc1 F_init
    s_add_u32 s47, s40, 3
    s_and_b32 s46, s47, 3
    s_lshl_b32 s48, s43, 2
    s_add_u32 s48, s48, s46
    s_lshl_b32 s49, s48, 1
    s_lshl_b32 s48, s48, 8
    s_and_b32 s47, s47, 8
    s_lshl_b32 s47, s47, 4
    s_add_u32 s48, s48, s47
    v_lshl_add_u32 v3, v0, 1, s48
    v_mov_b32 v5, s49
    s_lshl_b32 s47, s2, 2
    s_add_u32 s47, s47, s46
    s_lshl_b32 s47, s47, 11
    v_lshl_add_u32 v11, v0, 4, s47
    s_mulk_i32 s46, 2112
    s_add_u32 m0, s46, 65536
    v_mov_b64 v[52:53], 0
    v_mov_b64 v[72:73], 0
    v_mov_b64 v[94:95], 0
    v_mov_b32 v4, 0
    s_cmp_gt_u32 s40, 4
    s_waitcnt lgkmcnt(0)
    s_cbranch_scc1 E_par
    global_load_lds_dwordx4 v11, s[4:5]
    s_add_u32 m0, s46, 65568
    s_cmp_gt_u32 s40, 4
    global_load_lds_dwordx4 v11, s[4:5] offset:1024
E_par:
    global_load_short_d16_hi v52, v3, s[6:7]
    global_load_short_d16_hi v53, v3, s[8:9]
    global_load_short_d16_hi v72, v3, s[10:11]
    global_load_short_d16_hi v73, v3, s[12:13]
    global_load_short_d16_hi v94, v3, s[14:15]
    global_load_short_d16_hi v95, v3, s[16:17]
    global_load_short_d16_hi v4, v5, s[18:19]
    s_cbranch_scc1 A_main
    s_branch C_main
F_init:
    s_getpc_b64 s[52:53]
F_pc:
    s_mul_i32 s47, s42, 640
    v_lshl_add_u32 v1, v0, 7, s47
    v_min_u32 v1, L_code_end-F_pc-4, v1
    s_mov_b64 exec, 31
    global_load_dword v9, v1, s[52:53]
    s_mov_b64 exec, -1
    v_lshlrev_b32 v2, 4, v0
    v_mov_b32 v3, 0
    s_mov_b32 m0, 73984
    s_waitcnt lgkmcnt(0)
    global_load_dword v83, v3, s[36:37]
    global_load_lds_dwordx4 v2, s[24:25]
F_main:
    s_and_b32 s44, s42, 1
    s_mov_b32 s56, 0xffff0000
    s_add_u32 s46, s40, 3
    s_and_b32 s46, s46, 3
    v_lshlrev_b32 v2, 4, v0
    v_mov_b32 v4, 0x3f803f80
    v_mov_b32 v5, v4
    v_mov_b32 v6, v4
    v_mov_b32 v7, v4
    v_add_u32 v3, 87296, v2
    ds_write_b128 v3, v[4:7]
    v_bfe_u32 v1, v0, 2, 2
    v_and_b32 v2, 1, v0
    v_lshl_add_u32 v1, v1, 1, v2
    s_lshl_b32 s47, s2, 3
    s_sub_u32 s47, 0xffff, s47
    v_sub_u32 v70, s47, v1
    v_mul_u32_u24 v1, 1056, v1
    v_add_u32 v68, 65536, v1
    s_mov_b32 exec_lo, 0x44444444
    s_mov_b32 exec_hi, exec_lo
    v_mov_b32 v68, 87296
    s_mov_b32 exec_lo, 0x88888888
    s_mov_b32 exec_hi, exec_lo
    v_mov_b32 v68, 73984
    s_mov_b64 exec, -1
    v_and_b32 v1, 48, v0
    v_add_u32 v68, v1, v68
    s_lshl_b32 s47, s2, 6
    s_add_u32 s47, s47, 4096
    v_add_u32 v71, s47, v1
    s_lshl_b32 s45, s2, 5
    s_add_u32 s45, s45, 32768
    s_mul_i32 s16, s41, 43
    s_add_u32 s17, s16, 43
    s_lshr_b32 s16, s16, 1
    s_lshr_b32 s17, s17, 1
    s_add_u32 s18, s16, s42
    s_min_u32 s19, s18, 171
    v_and_b32 v1, 35, v0
    v_bfe_u32 v2, v0, 2, 2
    v_lshl_add_u32 v1, v2, 3, v1
    v_bfe_u32 v14, v0, 4, 1
    v_lshl_add_u32 v1, v14, 2, v1
    v_mul_u32_u24 v1, 2752, v1
    s_lshl_b32 s47, s19, 4
    v_add_u32 v85, s47, v1
    s_lshl_b32 s47, s19, 13
    v_lshl_add_u32 v86, v0, 4, s47
    v_mul_u32_u24 v2, 1088, v2
    v_and_b32 v1, 48, v0
    v_lshl_add_u32 v2, v1, 1, v2
    v_and_b32 v14, 3, v0
    v_lshl_add_u32 v2, v14, 3, v2
    v_add_u32 v88, 104832, v2
    v_and_b32 v14, 12, v0
    v_cmp_eq_u32 vcc, 4, v14
    v_mov_b32 v14, 86272
    v_mov_b32 v2, 87296
    v_cndmask_b32 v14, v14, v2, vcc
    v_add_u32 v89, v14, v1
    v_and_b32 v1, 60, v0
    v_lshlrev_b32 v1, 2, v1
    v_and_b32 v2, 1, v0
    v_lshl_add_u32 v1, v2, 3, v1
    v_bfe_u32 v2, v0, 1, 1
    s_movk_i32 s47, 8320
    v_mad_u32_u24 v1, v2, s47, v1
    v_add_u32 v87, 88320, v1
    v_lshrrev_b32 v1, 4, v0
    s_lshl_b32 s47, s43, 3
    v_lshl_add_u32 v90, v1, 1, s47
    v_mov_b64 v[96:97], 0
    v_mov_b64 v[98:99], 0
    v_mov_b64 v[100:101], 0
    v_mov_b64 v[102:103], 0
    v_mov_b64 v[104:105], 0
    v_mov_b64 v[106:107], 0
    v_mov_b64 v[108:109], 0
    v_mov_b64 v[110:111], 0
    s_mov_b64 s[60:61], s[26:27]
    s_mov_b32 s62, 1409024
    s_mov_b32 s63, 0x00020000
    s_mov_b64 s[64:65], s[28:29]
    s_mov_b32 s66, 1409024
    s_mov_b32 s67, 0x00020000
    s_mov_b32 s8, 0x00020001
    s_mov_b32 s9, 0x00080004
    s_mov_b32 s10, 0x00200010
    s_mov_b32 s11, 0x00800040
    s_mov_b32 s12, 0x02000100
    s_mov_b32 s13, 0x08000400
    s_mov_b32 s14, 0x20001000
    s_mov_b32 s15, 0x80004000
    s_mov_b32 s6, 0xaaaaaaaa
    s_mov_b32 s7, s6
    s_mov_b32 s22, 0xcccccccc
    s_mov_b32 s23, s22
    s_lshl_b32 s47, s42, 4
    v_lshrrev_b32 v1, 2, v0
    v_add_u32 v1, s47, v1
    v_mul_u32_u24 v1, 2752, v1
    s_lshl_b32 s47, s16, 4
    s_lshl_b32 s48, s17, 4
    v_add_u32 v2, s47, v1
    v_and_b32 v2, 0xffffff80, v2
    v_add_u32 v1, s48, v1
    v_and_b32 v14, 3, v0
    v_lshl_add_u32 v14, v14, 7, v2
    v_cmp_lt_u32 vcc, v14, v1
    s_nop 1
    v_cndmask_b32 v78, v2, v14, vcc
    s_mov_b64 s[68:69], s[36:37]
    s_mov_b32 s70, 3145728
    s_mov_b32 s71, 0x00020000
    s_mov_b32 s52, 0xaaaaaaaa
    s_mov_b32 s53, s52
    s_mov_b32 s48, 0x07060302
    s_mov_b32 s54, 0x00100001
    s_mov_b32 s55, 0x10000100
    v_mov_b32 v77, 86016
    v_mov_b32 v3, s45
    s_mov_b32 s47, 0x9E3779B1
    s_setprio 3
    s_waitcnt vmcnt(1)
    global_load_dword v79, v78, s[26:27]
    global_load_dword v84, v78, s[28:29]
    v_mov_b32 v82, 1
    s_barrier
    s_waitcnt vmcnt(2)
    ds_read_b128 v[4:7], v68 offset:0
    ds_read_b128 v[8:11], v68 offset:64
    ds_read_b128 v[12:15], v68 offset:128
    ds_read_b128 v[16:19], v68 offset:192
    v_mul_lo_u32 v83, v83, s47
    v_add_u32 v83, 1, v83
    ds_write_b64 v77, v[82:83] offset:24
    ds_read_b128 v[20:23], v68 offset:256
    s_waitcnt lgkmcnt(5)
    v_mfma_f32_16x16x32_bf16 v[72:75], v[4:7], v[4:7], 0
    ds_read_b128 v[24:27], v68 offset:320
    s_waitcnt lgkmcnt(5)
    v_mfma_f32_16x16x32_bf16 v[72:75], v[8:11], v[8:11], v[72:75]
    ds_read_b128 v[28:31], v68 offset:384
    s_waitcnt lgkmcnt(5)
    v_mfma_f32_16x16x32_bf16 v[72:75], v[12:15], v[12:15], v[72:75]
    ds_read_b128 v[32:35], v68 offset:448
    s_waitcnt lgkmcnt(5)
    v_mfma_f32_16x16x32_bf16 v[72:75], v[16:19], v[16:19], v[72:75]
    ds_read_b128 v[36:39], v68 offset:512
    s_waitcnt lgkmcnt(4)
    v_mfma_f32_16x16x32_bf16 v[72:75], v[20:23], v[20:23], v[72:75]
    ds_read_b128 v[40:43], v68 offset:576
    s_waitcnt lgkmcnt(4)
    v_mfma_f32_16x16x32_bf16 v[72:75], v[24:27], v[24:27], v[72:75]
    ds_read_b128 v[44:47], v68 offset:640
    s_waitcnt lgkmcnt(4)
    v_mfma_f32_16x16x32_bf16 v[72:75], v[28:31], v[28:31], v[72:75]
    ds_read_b128 v[48:51], v68 offset:704
    s_waitcnt lgkmcnt(4)
    v_mfma_f32_16x16x32_bf16 v[72:75], v[32:35], v[32:35], v[72:75]
    ds_read_b128 v[52:55], v68 offset:768
    s_waitcnt lgkmcnt(4)
    v_mfma_f32_16x16x32_bf16 v[72:75], v[36:39], v[36:39], v[72:75]
    ds_read_b128 v[56:59], v68 offset:832
    s_waitcnt lgkmcnt(4)
    v_mfma_f32_16x16x32_bf16 v[72:75], v[40:43], v[40:43], v[72:75]
    ds_read_b128 v[60:63], v68 offset:896
    s_waitcnt lgkmcnt(4)
    v_mfma_f32_16x16x32_bf16 v[72:75], v[44:47], v[44:47], v[72:75]
    ds_read_b128 v[64:67], v68 offset:960
    s_waitcnt lgkmcnt(4)
    v_mfma_f32_16x16x32_bf16 v[72:75], v[48:51], v[48:51], v[72:75]
    s_waitcnt lgkmcnt(3)
    v_mfma_f32_16x16x32_bf16 v[72:75], v[52:55], v[52:55], v[72:75]
    s_waitcnt lgkmcnt(2)
    v_mfma_f32_16x16x32_bf16 v[72:75], v[56:59], v[56:59], v[72:75]
    s_waitcnt lgkmcnt(1)
    v_mfma_f32_16x16x32_bf16 v[72:75], v[60:63], v[60:63], v[72:75]
    s_waitcnt lgkmcnt(0)
    v_mfma_f32_16x16x32_bf16 v[72:75], v[64:67], v[64:67], v[72:75]
    s_nop 7
    v_cndmask_b32 v5, v72, v73, s[52:53]
    v_mul_f32 v4, 0x3b000000, v74
    v_mul_f32 v5, 0x3b000000, v5
    v_fma_f32 v5, -v4, v4, v5
    v_max_f32 v5, 0, v5
    v_cvt_pk_bf16_f32 v5, v5, v5
    v_and_b32 v5, s56, v5
    v_add_f32 v5, 0x3727c5ac, v5
    v_cvt_pk_bf16_f32 v5, v5, v5
    v_and_b32 v5, s56, v5
    v_sqrt_f32 v5, v5
    v_cvt_pk_bf16_f32 v4, v4, v4
    v_cvt_pk_bf16_f32 v5, v5, v5
    v_and_b32 v4, s56, v4
    v_and_b32 v5, s56, v5
    v_rcp_f32 v80, v5
    v_mov_b32_dpp v7, v4 quad_perm:[1,1,1,1] row_mask:0xf bank_mask:0xf
    s_nop 0
    v_mov_b32_dpp v81, v80 quad_perm:[1,1,1,1] row_mask:0xf bank_mask:0xf
    v_perm_b32 v82, v7, v4, s48
    v_mov_b32_dpp v6, v74 quad_perm:[3,3,3,3] row_mask:0xf bank_mask:0xf
    s_mov_b64 exec, s[54:55]
    buffer_store_dwordx4 v[80:83], v71, s[68:71], 0 offen sc1
    s_mov_b64 exec, -1
    v_fma_f32 v7, -v4, v6, v75
    v_mul_f32 v7, v7, v80
    v_cvt_pk_bf16_f32 v7, v7, v7
    v_ashrrev_i32 v8, 31, v7
    v_or_b32 v8, 0x80000000, v8
    v_xor_b32 v7, v7, v8
    v_and_or_b32 v7, v7, s56, v70
    v_mov_b32 v13, v83
    v_readfirstlane_b32 s39, v83
    v_max_u32_dpp v7, v7, v7 quad_perm:[1,0,3,2] row_mask:0xf bank_mask:0xf
    s_nop 0
    v_readlane_b32 s47, v7, 0
    v_readlane_b32 s48, v7, 20
    v_readlane_b32 s49, v7, 40
    v_readlane_b32 s50, v7, 60
    s_max_u32 s47, s47, s48
    s_max_u32 s49, s49, s50
    s_max_u32 s47, s47, s49
    v_mov_b32 v12, s47
    s_mov_b64 exec, 1
    buffer_store_dwordx2 v[12:13], v3, s[68:71], 0 offen sc1
    s_mov_b64 exec, -1
    v_lshlrev_b32 v76, 5, v0
    v_add_u32 v76, 32768, v76
    s_movk_i32 s58, 2048
    s_movk_i32 s59, 4096
    s_movk_i32 s46, 6144
    s_mov_b32 s57, 100000
    s_setprio 0
    s_cmp_ge_u32 s18, s17
    s_cbranch_scc1 F_b0
    s_waitcnt vmcnt(2)
    s_mov_b32 m0, 88320
    s_mov_b32 s47, 0
    buffer_load_dwordx4 v85, s[60:63], s47 offen lds
    s_mov_b32 m0, 96640
    s_mov_b32 s47, 0
    buffer_load_dwordx4 v85, s[64:67], s47 offen lds
    s_mov_b32 m0, 89344
    s_mov_b32 s47, 176128
    buffer_load_dwordx4 v85, s[60:63], s47 offen lds
    s_mov_b32 m0, 97664
    s_mov_b32 s47, 176128
    buffer_load_dwordx4 v85, s[64:67], s47 offen lds
    s_mov_b32 m0, 90368
    s_mov_b32 s47, 352256
    buffer_load_dwordx4 v85, s[60:63], s47 offen lds
    s_mov_b32 m0, 98688
    s_mov_b32 s47, 352256
    buffer_load_dwordx4 v85, s[64:67], s47 offen lds
    s_mov_b32 m0, 91392
    s_mov_b32 s47, 528384
    buffer_load_dwordx4 v85, s[60:63], s47 offen lds
    s_mov_b32 m0, 99712
    s_mov_b32 s47, 528384
    buffer_load_dwordx4 v85, s[64:67], s47 offen lds
    s_mov_b32 m0, 92416
    s_mov_b32 s47, 704512
    buffer_load_dwordx4 v85, s[60:63], s47 offen lds
    s_mov_b32 m0, 100736
    s_mov_b32 s47, 704512
    buffer_load_dwordx4 v85, s[64:67], s47 offen lds
    s_waitcnt vmcnt(10)
    s_branch F_b1
F_b0:
    s_waitcnt vmcnt(0)
F_b1:
    s_setprio 3
    s_waitcnt lgkmcnt(0)
    s_barrier
    buffer_load_dwordx2 v[4:5], v76, s[68:71], 0 offen sc1
    buffer_load_dwordx2 v[6:7], v76, s[68:71], s58 offen sc1
    buffer_load_dwordx2 v[8:9], v76, s[68:71], s59 offen sc1
    buffer_load_dwordx2 v[10:11], v76, s[68:71], s46 offen sc1
    s_setprio 0
    s_cmp_ge_u32 s18, s17
    s_cbranch_scc1 F_kwait
    s_setprio 3
    s_waitcnt vmcnt(0)
    s_branch F_kchk
F_kpoll:
    buffer_load_dwordx2 v[4:5], v76, s[68:71], 0 offen sc1
    buffer_load_dwordx2 v[6:7], v76, s[68:71], s58 offen sc1
    buffer_load_dwordx2 v[8:9], v76, s[68:71], s59 offen sc1
    buffer_load_dwordx2 v[10:11], v76, s[68:71], s46 offen sc1
F_kwait:
    s_setprio 3
    s_waitcnt vmcnt(0)
F_kchk:
    v_xor_b32 v5, v83, v5
    v_xor_b32 v7, v83, v7
    v_xor_b32 v9, v83, v9
    v_xor_b32 v11, v83, v11
    v_or3_b32 v5, v5, v7, v9
    v_or_b32 v5, v5, v11
    v_cmp_ne_u32 vcc, 0, v5
    v_max3_u32 v4, v4, v6, v8
    v_max_u32 v4, v4, v10
    s_cmp_eq_u64 vcc, 0
    s_cbranch_scc1 F_kgot
    s_sub_u32 s57, s57, 1
    s_cmp_lg_u32 s57, 0
    s_cbranch_scc1 F_kpoll
F_kgot:
    v_max_u32_dpp v4, v4, v4 row_ror:8 row_mask:0xf bank_mask:0xf
    s_nop 1
    v_max_u32_dpp v4, v4, v4 row_ror:4 row_mask:0xf bank_mask:0xf
    s_nop 1
    v_max_u32_dpp v4, v4, v4 row_ror:2 row_mask:0xf bank_mask:0xf
    s_nop 1
    v_max_u32_dpp v4, v4, v4 row_ror:1 row_mask:0xf bank_mask:0xf
    s_nop 0
    v_readlane_b32 s47, v4, 0
    v_readlane_b32 s48, v4, 16
    v_readlane_b32 s49, v4, 32
    v_readlane_b32 s54, v4, 48
    s_max_u32 s47, s47, s48
    s_max_u32 s49, s49, s54
    s_max_u32 s55, s47, s49
    s_and_b32 s47, s55, 0xffff
    s_sub_u32 s54, 0xffff, s47
    s_and_b32 s54, s54, 2047
    s_lshl_b32 s47, s54, 10
    v_lshl_add_u32 v1, v0, 4, s47
    s_mov_b32 m0, 86272
    global_load_ushort v69, v90, s[20:21]
    v_add_u32 v90, s47, v90
    global_load_lds_dwordx4 v1, s[4:5]
    s_lshr_b32 s48, s54, 1
    s_lshl_b32 s48, s48, 4
    s_add_u32 s48, s48, 4096
    v_mov_b32 v2, s48
    buffer_load_dwordx4 v[92:95], v2, s[68:71], 0 offen sc1
    global_load_ushort v91, v90, s[4:5]
    s_add_u32 s47, s54, 1
    v_mov_b32 v2, s47
    ds_write_b32 v77, v2 offset:16
    s_cmp_ge_u32 s18, s17
    s_cbranch_scc1 F_nounit
    s_setprio 0
    s_mov_b32 m0, 93440
    s_mov_b32 s47, 880640
    buffer_load_dwordx4 v85, s[60:63], s47 offen lds
    s_mov_b32 m0, 101760
    s_mov_b32 s47, 880640
    buffer_load_dwordx4 v85, s[64:67], s47 offen lds
    s_mov_b32 m0, 94464
    s_mov_b32 s47, 1056768
    buffer_load_dwordx4 v85, s[60:63], s47 offen lds
    s_mov_b32 m0, 102784
    s_mov_b32 s47, 1056768
    buffer_load_dwordx4 v85, s[64:67], s47 offen lds
    s_mov_b32 m0, 95488
    s_mov_b32 s47, 1232896
    buffer_load_dwordx4 v85, s[60:63], s47 offen lds
    s_mov_b32 m0, 103808
    s_mov_b32 s47, 1232896
    buffer_load_dwordx4 v85, s[64:67], s47 offen lds
    s_mov_b32 s57, 4000000
F_c_w:
    ds_read_b128 v[16:19], v77 offset:32
    s_waitcnt lgkmcnt(0)
    v_min3_u32 v16, v16, v17, v18
    v_min_u32 v16, v16, v19
    s_nop 0
    v_readfirstlane_b32 s47, v16
    s_nop 0
    s_cmp_lg_u32 s47, 0
    s_cbranch_scc1 F_c_g
    s_sleep 1
    s_sub_u32 s57, s57, 1
    s_cmp_lg_u32 s57, 0
    s_cbranch_scc1 F_c_w
F_c_g:
    s_setprio 3
    v_add_u32 v1, 4096, v86
    s_mov_b32 m0, 104832
    s_nop 0
    global_load_lds_dwordx4 v86, s[30:31] offset:0
    s_mov_b32 m0, 104896
    s_nop 0
    global_load_lds_dwordx4 v86, s[30:31] offset:1024
    s_mov_b32 m0, 104960
    s_nop 0
    global_load_lds_dwordx4 v86, s[30:31] offset:2048
    s_mov_b32 m0, 105024
    s_nop 0
    global_load_lds_dwordx4 v86, s[30:31] offset:3072
    s_mov_b32 m0, 109184
    s_nop 0
    global_load_lds_dwordx4 v1, s[30:31] offset:0
    s_mov_b32 m0, 109248
    s_nop 0
    global_load_lds_dwordx4 v1, s[30:31] offset:1024
    s_mov_b32 m0, 109312
    s_nop 0
    global_load_lds_dwordx4 v1, s[30:31] offset:2048
    s_mov_b32 m0, 109376
    s_nop 0
    global_load_lds_dwordx4 v1, s[30:31] offset:3072
    s_setprio 3
    s_waitcnt vmcnt(14)
    ds_read_b64_tr_b16 v[112:113], v87 offset:0
    ds_read_b64_tr_b16 v[114:115], v87 offset:256
    ds_read_b128 v[4:7], v89 offset:0
    ds_read_b64_tr_b16 v[116:117], v87 offset:512
    ds_read_b64_tr_b16 v[118:119], v87 offset:768
    ds_read_b128 v[8:11], v89 offset:64
    ds_read_b64_tr_b16 v[120:121], v87 offset:1024
    ds_read_b64_tr_b16 v[122:123], v87 offset:1280
    ds_read_b128 v[12:15], v89 offset:128
    ds_read_b64_tr_b16 v[124:125], v87 offset:1536
    ds_read_b64_tr_b16 v[126:127], v87 offset:1792
    ds_read_b128 v[16:19], v89 offset:192
    s_and_b32 s47, s54, 1
    s_cmp_eq_u32 s47, 1
    s_cselect_b64 vcc, -1, 0
    s_cselect_b32 s47, 0, 16
    v_cndmask_b32 v92, v92, v93, vcc
    v_lshlrev_b32 v93, s47, v94
    v_and_b32 v93, s56, v93
    v_mul_f32 v93, -v93, v92
    ds_read_b64_tr_b16 v[128:129], v87 offset:2048
    ds_read_b64_tr_b16 v[130:131], v87 offset:2304
    ds_read_b128 v[20:23], v89 offset:256
    s_waitcnt lgkmcnt(12)
    v_mfma_f32_16x16x32_bf16 v[72:75], v[112:115], v[4:7], 0
    ds_read_b64_tr_b16 v[132:133], v87 offset:2560
    ds_read_b64_tr_b16 v[134:135], v87 offset:2816
    ds_read_b128 v[24:27], v89 offset:320
    s_waitcnt lgkmcnt(12)
    v_mfma_f32_16x16x32_bf16 v[72:75], v[116:119], v[8:11], v[72:75]
    ds_read_b64_tr_b16 v[136:137], v87 offset:3072
    ds_read_b64_tr_b16 v[138:139], v87 offset:3328
    ds_read_b128 v[28:31], v89 offset:384
    s_waitcnt lgkmcnt(12)
    v_mfma_f32_16x16x32_bf16 v[72:75], v[120:123], v[12:15], v[72:75]
    ds_read_b64_tr_b16 v[140:141], v87 offset:3584
    ds_read_b64_tr_b16 v[142:143], v87 offset:3840
    ds_read_b128 v[32:35], v89 offset:448
    s_waitcnt lgkmcnt(12)
    v_mfma_f32_16x16x32_bf16 v[72:75], v[124:127], v[16:19], v[72:75]
    ds_read_b64_tr_b16 v[112:113], v87 offset:4096
    ds_read_b64_tr_b16 v[114:115], v87 offset:4352
    ds_read_b128 v[36:39], v89 offset:512
    s_waitcnt lgkmcnt(12)
    v_mfma_f32_16x16x32_bf16 v[72:75], v[128:131], v[20:23], v[72:75]
    ds_read_b64_tr_b16 v[116:117], v87 offset:4608
    ds_read_b64_tr_b16 v[118:119], v87 offset:4864
    ds_read_b128 v[56:59], v89 offset:576
    s_waitcnt lgkmcnt(12)
    v_mfma_f32_16x16x32_bf16 v[72:75], v[132:135], v[24:27], v[72:75]
    s_waitcnt vmcnt(12)
    s_setprio 3
    ds_read_b64_tr_b16 v[120:121], v87 offset:5120
    ds_read_b64_tr_b16 v[122:123], v87 offset:5376
    ds_read_b128 v[60:63], v89 offset:640
    s_waitcnt lgkmcnt(12)
    v_mfma_f32_16x16x32_bf16 v[72:75], v[136:139], v[28:31], v[72:75]
    ds_read_b64_tr_b16 v[124:125], v87 offset:5632
    ds_read_b64_tr_b16 v[126:127], v87 offset:5888
    ds_read_b128 v[64:67], v89 offset:704
    s_waitcnt lgkmcnt(12)
    v_mfma_f32_16x16x32_bf16 v[72:75], v[140:143], v[32:35], v[72:75]
    s_waitcnt vmcnt(10)
    ds_read_b64_tr_b16 v[128:129], v87 offset:6144
    ds_read_b64_tr_b16 v[130:131], v87 offset:6400
    ds_read_b128 v[144:147], v89 offset:768
    s_waitcnt lgkmcnt(12)
    v_mfma_f32_16x16x32_bf16 v[72:75], v[112:115], v[36:39], v[72:75]
    ds_read_b64_tr_b16 v[132:133], v87 offset:6656
    ds_read_b64_tr_b16 v[134:135], v87 offset:6912
    ds_read_b128 v[148:151], v89 offset:832
    s_waitcnt lgkmcnt(12)
    v_mfma_f32_16x16x32_bf16 v[72:75], v[116:119], v[56:59], v[72:75]
    s_waitcnt vmcnt(8)
    ds_read_b64_tr_b16 v[136:137], v87 offset:7168
    ds_read_b64_tr_b16 v[138:139], v87 offset:7424
    ds_read_b128 v[152:155], v89 offset:896
    s_waitcnt lgkmcnt(12)
    v_mfma_f32_16x16x32_bf16 v[72:75], v[120:123], v[60:63], v[72:75]
    ds_read_b64_tr_b16 v[140:141], v87 offset:7680
    ds_read_b64_tr_b16 v[142:143], v87 offset:7936
    ds_read_b128 v[156:159], v89 offset:960
    s_waitcnt lgkmcnt(12)
    v_mfma_f32_16x16x32_bf16 v[72:75], v[124:127], v[64:67], v[72:75]
    s_waitcnt lgkmcnt(9)
    v_mfma_f32_16x16x32_bf16 v[72:75], v[128:131], v[144:147], v[72:75]
    s_waitcnt lgkmcnt(6)
    v_mfma_f32_16x16x32_bf16 v[72:75], v[132:135], v[148:151], v[72:75]
    s_waitcnt lgkmcnt(3)
    v_mfma_f32_16x16x32_bf16 v[72:75], v[136:139], v[152:155], v[72:75]
    s_waitcnt lgkmcnt(0)
    v_mfma_f32_16x16x32_bf16 v[72:75], v[140:143], v[156:159], v[72:75]
    s_setprio 3
    s_waitcnt vmcnt(0)
    ds_read_b64_tr_b16 v[112:113], v88 offset:0
    ds_read_b64_tr_b16 v[114:115], v88 offset:4352
    ds_read_b64_tr_b16 v[116:117], v88 offset:128
    ds_read_b64_tr_b16 v[118:119], v88 offset:4480
    s_nop 1
    v_cndmask_b32 v40, v72, v73, s[6:7]
    ds_read_b64_tr_b16 v[120:121], v88 offset:256
    v_cndmask_b32 v41, v74, v75, s[6:7]
    v_cndmask_b32 v40, v40, v41, s[22:23]
    ds_read_b64_tr_b16 v[122:123], v88 offset:4608
    v_mul_f32 v44, v40, v92
    s_lshl_b32 s47, s18, 11
    ds_read_b64_tr_b16 v[124:125], v88 offset:384
    v_fmac_f32_dpp v44, v40, v93 row_shl:4 row_mask:0xf bank_mask:0xf
    v_cvt_pk_bf16_f32 v44, v44, v44
    v_and_b32 v44, s56, v44
    ds_read_b64_tr_b16 v[126:127], v88 offset:4736
    s_add_u32 s47, s47, 196608
    s_mov_b32 s64, 0x07060500
    ds_read_b64_tr_b16 v[128:129], v88 offset:512
    v_permlane32_swap_b32 v44, v45
    v_mul_f32 v46, 0xbfb8aa3b, v44
    v_exp_f32 v46, v46
    ds_read_b64_tr_b16 v[130:131], v88 offset:4864
    s_mov_b32 s65, 0x07060501
    v_add_f32 v46, 1.0, v46
    ds_read_b64_tr_b16 v[132:133], v88 offset:640
    v_rcp_f32 v46, v46
    s_mov_b32 s66, 0x07060502
    ds_read_b64_tr_b16 v[134:135], v88 offset:4992
    v_mul_f32 v44, v44, v46
    v_cvt_pk_bf16_f32 v44, v44, v44
    v_and_b32 v44, s56, v44
    ds_read_b64_tr_b16 v[136:137], v88 offset:768
    v_mul_f32 v44, v44, v45
    s_mov_b32 s67, 0x07060503
    ds_read_b64_tr_b16 v[138:139], v88 offset:5120
    v_lshl_add_u32 v1, v0, 4, s47
    v_mov_b32_dpp v46, v44 quad_perm:[1,1,3,3] row_mask:0xf bank_mask:0xf
    v_cvt_pk_bf16_f32 v40, v44, v46
    ds_read_b64_tr_b16 v[140:141], v88 offset:896
    v_readlane_b32 s60, v40, 0
    v_readlane_b32 s61, v40, 2
    ds_read_b64_tr_b16 v[142:143], v88 offset:5248
    v_readlane_b32 s62, v40, 16
    v_readlane_b32 s63, v40, 18
    s_mov_b64 exec, s[8:9]
    v_mov_b64 v[96:97], s[60:61]
    v_mov_b64 v[98:99], s[62:63]
    s_mov_b64 exec, s[10:11]
    v_mov_b64 v[100:101], s[60:61]
    v_mov_b64 v[102:103], s[62:63]
    s_mov_b64 exec, s[12:13]
    v_mov_b64 v[104:105], s[60:61]
    v_mov_b64 v[106:107], s[62:63]
    s_mov_b64 exec, s[14:15]
    v_mov_b64 v[108:109], s[60:61]
    v_mov_b64 v[110:111], s[62:63]
    s_mov_b64 exec, -1
    s_setprio 3
    s_waitcnt lgkmcnt(0)
    v_mfma_f32_16x16x32_bf16 v[4:7], v[112:115], v[96:99], 0
    v_mfma_f32_16x16x32_bf16 v[8:11], v[128:131], v[96:99], 0
    v_mfma_f32_16x16x32_bf16 v[4:7], v[116:119], v[100:103], v[4:7]
    v_mfma_f32_16x16x32_bf16 v[8:11], v[132:135], v[100:103], v[8:11]
    v_mfma_f32_16x16x32_bf16 v[4:7], v[120:123], v[104:107], v[4:7]
    v_mfma_f32_16x16x32_bf16 v[8:11], v[136:139], v[104:107], v[8:11]
    v_mfma_f32_16x16x32_bf16 v[4:7], v[124:127], v[108:111], v[4:7]
    v_mfma_f32_16x16x32_bf16 v[8:11], v[140:143], v[108:111], v[8:11]
    s_nop 6
    v_perm_b32 v4, v4, v83, s64
    v_perm_b32 v5, v5, v83, s65
    v_perm_b32 v6, v6, v83, s66
    v_perm_b32 v7, v7, v83, s67
    buffer_store_dwordx4 v[4:7], v1, s[68:71], 0 offen offset:0 sc1
    v_perm_b32 v8, v8, v83, s64
    v_perm_b32 v9, v9, v83, s65
    v_perm_b32 v10, v10, v83, s66
    v_perm_b32 v11, v11, v83, s67
    buffer_store_dwordx4 v[8:11], v1, s[68:71], 0 offen offset:1024 sc1
    s_branch F_row
F_nounit:
    s_waitcnt vmcnt(0)
    s_and_b32 s47, s54, 1
    s_cmp_eq_u32 s47, 1
    s_cselect_b64 vcc, -1, 0
    s_cselect_b32 s47, 0, 16
    v_cndmask_b32 v92, v92, v93, vcc
    v_lshlrev_b32 v93, s47, v94
    v_and_b32 v93, s56, v93
    v_mul_f32 v93, -v93, v92
F_row:
    s_setprio 3
    s_and_b32 s47, s54, 1
    s_cmp_lg_u32 s47, s44
    s_cbranch_scc1 F_done
    s_ashr_i32 s47, s55, 31
    s_not_b32 s47, s47
    s_or_b32 s47, s47, 0x80000000
    s_xor_b32 s47, s47, s55
    s_and_b32 s47, s47, 0xffff0000
    v_mov_b32 v25, s47
    v_mul_f32 v25, 0xbfb8aa3b, v25
    v_exp_f32 v25, v25
    s_nop 0
    v_add_f32 v25, 1.0, v25
    v_rcp_f32 v25, v25
    s_nop 0
    v_cvt_pk_bf16_f32 v25, v25, v25
    v_and_b32 v25, s56, v25
    s_lshr_b32 s47, s54, 9
    s_mul_i32 s47, s47, 1280
    s_bfe_u32 s48, s54, 0x20003
    s_mul_i32 s48, s48, 288
    s_add_u32 s47, s47, s48
    s_bfe_u32 s48, s54, 0x40005
    s_lshl_b32 s48, s48, 4
    s_add_u32 s47, s47, s48
    s_bfe_u32 s48, s54, 0x20001
    s_lshl_b32 s48, s48, 2
    s_add_u32 s47, s47, s48
    s_add_u32 s47, s47, 9024
    v_lshrrev_b32 v26, 4, v0
    v_lshlrev_b32 v33, 14, v26
    v_lshl_add_u32 v26, v26, 14, s47
    s_lshr_b32 s47, s43, 6
    s_lshl_b32 s47, s47, 10
    s_bfe_u32 s48, s43, 0x40002
    s_lshl_b32 s48, s48, 4
    s_add_u32 s47, s47, s48
    s_and_b32 s48, s43, 3
    s_lshl_b32 s48, s48, 8
    s_add_u32 s47, s47, s48
    s_add_u32 s47, s47, 196608
    v_lshl_add_u32 v27, v0, 11, s47
    v_add_u32 v28, 0x20000, v27
    v_min_u32 v29, 43, v0
    v_lshl_add_u32 v29, v29, 11, s47
    v_add_u32 v29, 0x40000, v29
    s_mov_b32 s58, 0x0c0c0400
    s_mov_b32 s59, 0x04000c0c
    s_mov_b32 s57, 4000000
F_p_w:
    ds_read_b32 v16, v77
    s_waitcnt lgkmcnt(0)
    v_readfirstlane_b32 s47, v16
    s_nop 0
    s_lshr_b32 s47, s47, 1
    s_cmp_lg_u32 s47, 0
    s_cbranch_scc1 F_p_g
    s_sleep 1
    s_sub_u32 s57, s57, 1
    s_cmp_lg_u32 s57, 0
    s_cbranch_scc1 F_p_w
F_p_g:
    s_mov_b32 s57, 100000
    s_waitcnt vmcnt(0)
    v_lshlrev_b32 v91, 16, v91
    v_fma_f32 v24, v91, v92, v93
    v_cvt_pk_bf16_f32 v24, v24, v24
    v_and_b32 v24, s56, v24
    s_setprio 3
    buffer_load_dwordx4 v[12:15], v27, s[68:71], 0 offen sc1
    buffer_load_dwordx4 v[16:19], v28, s[68:71], 0 offen sc1
    buffer_load_dwordx4 v[20:23], v29, s[68:71], 0 offen sc1
    s_mov_b32 s57, 4000000
F_y_w:
    ds_read_b128 v[4:7], v77 offset:0
    s_waitcnt lgkmcnt(0)
    v_min3_u32 v4, v4, v5, v6
    v_min_u32 v4, v4, v7
    s_nop 0
    v_readfirstlane_b32 s47, v4
    s_nop 0
    s_lshr_b32 s47, s47, 2
    s_cmp_lg_u32 s47, 0
    s_cbranch_scc1 F_y_g
    s_sleep 1
    s_sub_u32 s57, s57, 1
    s_cmp_lg_u32 s57, 0
    s_cbranch_scc1 F_y_w
F_y_g:
    ds_read_b32 v32, v26
    ds_read_b32 v33, v33 offset:8960
    v_lshlrev_b32 v69, 16, v69
    v_mul_f32 v34, v24, v69
    v_cvt_pk_bf16_f32 v34, v34, v34
    v_and_b32 v34, s56, v34
    s_mov_b32 s57, 100000
    s_waitcnt lgkmcnt(0)
    v_cvt_pk_bf16_f32 v35, v33, v33
    v_sub_f32 v33, v69, v33
    v_and_b32 v35, s56, v35
    v_add_f32 v33, v33, v35
    v_fma_f32 v32, -v24, v33, v32
    v_cvt_pk_bf16_f32 v32, v32, v32
    v_and_b32 v32, s56, v32
    v_add_f32 v32, v32, v34
    v_cvt_pk_bf16_f32 v32, v32, v32
    v_and_b32 v32, s56, v32
    s_branch F_pw
F_poll:
    s_mov_b64 exec, s[60:61]
    s_cbranch_execz F_pl0
    buffer_load_dwordx4 v[12:15], v27, s[68:71], 0 offen sc1
F_pl0:
    s_mov_b64 exec, s[62:63]
    s_cbranch_execz F_pl1
    buffer_load_dwordx4 v[16:19], v28, s[68:71], 0 offen sc1
F_pl1:
    s_mov_b64 exec, s[64:65]
    s_cbranch_execz F_pl2
    buffer_load_dwordx4 v[20:23], v29, s[68:71], 0 offen sc1
F_pl2:
    s_mov_b64 exec, -1
F_pw:
    s_waitcnt vmcnt(0)
    v_perm_b32 v30, v13, v12, s58
    v_perm_b32 v31, v15, v14, s59
    v_or_b32 v30, v30, v31
    v_cmp_ne_u32 s[60:61], s39, v30
    v_perm_b32 v30, v17, v16, s58
    v_perm_b32 v31, v19, v18, s59
    v_or_b32 v30, v30, v31
    v_cmp_ne_u32 s[62:63], s39, v30
    v_perm_b32 v30, v21, v20, s58
    v_perm_b32 v31, v23, v22, s59
    v_or_b32 v30, v30, v31
    v_cmp_ne_u32 s[64:65], s39, v30
    s_or_b64 s[48:49], s[60:61], s[62:63]
    s_or_b64 s[48:49], s[48:49], s[64:65]
    s_cbranch_scc0 F_got
    s_sleep 0
    s_sub_u32 s57, s57, 1
    s_cmp_lg_u32 s57, 0
    s_cbranch_scc1 F_poll
F_got:
    v_and_b32 v12, 0xffffff00, v12
    v_and_b32 v13, 0xffffff00, v13
    v_and_b32 v14, 0xffffff00, v14
    v_and_b32 v15, 0xffffff00, v15
    v_and_b32 v16, 0xffffff00, v16
    v_and_b32 v17, 0xffffff00, v17
    v_and_b32 v18, 0xffffff00, v18
    v_and_b32 v19, 0xffffff00, v19
    v_and_b32 v20, 0xffffff00, v20
    v_and_b32 v21, 0xffffff00, v21
    v_and_b32 v22, 0xffffff00, v22
    v_and_b32 v23, 0xffffff00, v23
    v_add_f32 v12, v12, v16
    v_add_f32 v13, v13, v17
    v_add_f32 v14, v14, v18
    v_add_f32 v15, v15, v19
    s_mov_b32 exec_hi, 0xfff
    v_add_f32 v12, v12, v20
    v_add_f32 v13, v13, v21
    v_add_f32 v14, v14, v22
    v_add_f32 v15, v15, v23
    s_mov_b64 exec, -1
    v_permlane32_swap_b32 v12, v14
    v_permlane32_swap_b32 v13, v15
    v_add_f32 v12, v12, v14
    v_add_f32 v13, v13, v15
    s_nop 1
    v_permlane16_swap_b32 v12, v13
    v_add_f32 v12, v12, v13
    s_nop 1
    v_add_f32_dpp v12, v12, v12 row_ror:8 row_mask:0xf bank_mask:0xf
    s_nop 1
    v_add_f32_dpp v12, v12, v12 row_ror:4 row_mask:0xf bank_mask:0xf
    s_nop 1
    v_add_f32_dpp v12, v12, v12 row_ror:2 row_mask:0xf bank_mask:0xf
    s_nop 1
    v_add_f32_dpp v12, v12, v12 row_ror:1 row_mask:0xf bank_mask:0xf
    v_cvt_pk_bf16_f32 v12, v12, v12
    v_and_b32 v12, s56, v12
    v_mul_f32 v12, v12, v25
    v_cvt_pk_bf16_f32 v12, v12, v12
    v_and_b32 v12, s56, v12
    v_add_f32 v12, v12, v24
    v_cvt_pk_bf16_f32 v12, v12, v12
    v_and_b32 v12, s56, v12
    v_mul_f32 v13, 0xbfb8aa3b, v12
    v_exp_f32 v13, v13
    s_nop 0
    v_add_f32 v13, 1.0, v13
    v_rcp_f32 v13, v13
    s_nop 0
    v_mul_f32 v12, v12, v13
    v_cvt_pk_bf16_f32 v12, v12, v12
    v_and_b32 v12, s56, v12
    v_mul_f32 v13, v32, v12
    v_cvt_pk_bf16_f32 v13, v13, v13
    v_and_b32 v13, s56, v13
    v_add_f32 v13, v13, v91
    v_cvt_pk_bf16_f32 v13, v13, v13
    s_mov_b32 exec_lo, 0x00010001
    s_mov_b32 exec_hi, 0x00010001
    global_store_short v90, v13, s[32:33]
F_done:
L_end:
    s_endpgm
C_main:
    v_mov_b64 v[6:7], 0
    s_mov_b64 exec, 1
    global_load_short_d16_hi v7, v5, s[20:21]
    s_mov_b64 exec, -1
    s_setprio 2
    s_and_b32 s44, s42, 1
    s_mov_b32 s56, 0xffff0000
    s_add_u32 s46, s40, 3
    s_and_b32 s46, s46, 3
    s_lshl_b32 s47, s2, 13
    v_and_b32 v10, 60, v0
    v_and_b32 v2, 3, v0
    s_lshl_b32 s45, s46, 14
    s_mov_b32 m0, s45
    s_mov_b32 s72, 0x9e37f1b5
    s_mov_b32 s73, 0x7b45c2d3
    s_mov_b32 s74, 0x5a8d3ee9
    s_mov_b32 s75, 0xc3a5b671
    v_mul_u32_u24 v107, 7, v2
    s_lshl_b32 s48, s46, 11
    s_add_u32 s47, s47, s48
    s_add_u32 s47, s47, 1048576
    v_lshl_add_u32 v108, v0, 4, s47
    s_and_b32 s47, s2, 63
    s_lshl_b32 s47, s47, 2
    s_lshr_b32 s48, s2, 6
    s_add_u32 s47, s47, s48
    s_lshl_b32 s47, s47, 6
    s_lshl_b32 s48, s46, 15
    s_add_u32 s47, s47, s48
    s_add_u32 s47, s47, 65536
    v_lshl_add_u32 v109, v2, 14, s47
    v_add_u32 v109, v10, v109
    s_lshl_b32 s47, s46, 8
    s_add_u32 s47, s47, 65536
    v_mul_u32_u24 v110, 2112, v2
    v_lshl_add_u32 v110, v10, 1, v110
    v_add_u32 v110, s47, v110
    s_mov_b32 s64, 0x3fb8aa3b
    s_mov_b32 s65, 0x3e22f983
    s_mov_b32 s66, 0x43b8aa3b
    s_mov_b32 s67, 0x4222f983
    v_mov_b32 v35, 0x3f80
    ds_write_addtid_b32 v35 offset:0
    v_and_b32 v1, 15, v0
    v_lshrrev_b32 v2, 4, v0
    s_add_u32 s47, s45, 64
    s_movk_i32 s52, 4484
    v_and_b32 v3, 1, v0
    v_lshl_add_u32 v20, v2, 4, s47
    v_mad_u32_u24 v20, v3, s52, v20
    v_lshlrev_b32 v3, 2, v1
    v_sub_u32 v20, v20, v3
    s_add_u32 s47, s45, 9024
    s_movk_i32 s52, 288
    v_lshl_add_u32 v34, v1, 4, s47
    v_mad_u32_u24 v34, v2, s52, v34
    s_mul_i32 s47, s46, 5120
    s_add_u32 s47, s47, 65600
    v_lshl_add_u32 v1, v1, 6, s47
    v_lshl_add_u32 v1, v2, 4, v1
    v_xor_b32 v2, 32, v1
    s_mov_b32 vcc_lo, 0xf0f0f0f0
    s_mov_b32 vcc_hi, vcc_lo
    v_cndmask_b32 v21, v1, v2, vcc
    v_cndmask_b32 v25, v2, v1, vcc
    s_mov_b32 vcc_lo, 0xe1e1e1e1
    s_mov_b32 vcc_hi, vcc_lo
    v_cndmask_b32 v22, v1, v2, vcc
    v_cndmask_b32 v26, v2, v1, vcc
    s_mov_b32 vcc_lo, 0xc3c3c3c3
    s_mov_b32 vcc_hi, vcc_lo
    v_cndmask_b32 v23, v1, v2, vcc
    v_cndmask_b32 v27, v2, v1, vcc
    s_mov_b32 vcc_lo, 0x87878787
    s_mov_b32 vcc_hi, vcc_lo
    v_cndmask_b32 v24, v1, v2, vcc
    v_cndmask_b32 v28, v2, v1, vcc
    v_and_b32 v1, 31, v0
    v_lshrrev_b32 v2, 5, v0
    s_movk_i32 s52, 272
    v_lshl_add_u32 v29, v2, 4, s45
    v_mad_u32_u24 v29, v1, s52, v29
    s_add_u32 s48, s45, 8960
    s_add_u32 s47, s44, 2048
    s_sub_u32 s59, s48, 68100
    v_lshl_add_u32 v30, v2, 4, s48
    v_lshl_add_u32 v30, v1, 5, v30
    s_movk_i32 s52, 248
    v_sub_u32 v3, 4, v2
    v_lshlrev_b32 v3, v3, v1
    v_lshl_add_u32 v9, v2, 9, s48
    v_add_u32 v31, v3, v9
    v_mad_u32_u24 v32, v2, s52, v31
    v_lshl_add_u32 v33, v1, 2, v9
    v_lshlrev_b32 v1, 1, v0
    v_sub_u32 v1, s47, v1
    v_cvt_f32_u32 v1, v1
    v_add_f32 v2, 0xc4600000, v1
    v_add_f32 v3, 0xc4604000, v1
    v_cvt_pk_bf16_f32 v2, v2, v3
    v_mad_u32_u16 v10, v2, 4, s59
    v_cmp_eq_u32_sdwa s[4:5], v2, v2 src0_sel:WORD_0 src1_sel:WORD_1
    v_add_f32 v2, 0xc4b00000, v1
    v_add_f32 v3, 0xc4b02000, v1
    v_cvt_pk_bf16_f32 v2, v2, v3
    v_mad_u32_u16 v11, v2, 4, s59
    v_cmp_eq_u32_sdwa s[6:7], v2, v2 src0_sel:WORD_0 src1_sel:WORD_1
    v_add_f32 v2, 0xc4d00000, v1
    v_add_f32 v3, 0xc4d02000, v1
    v_cvt_pk_bf16_f32 v2, v2, v3
    v_mad_u32_u16 v12, v2, 4, s59
    v_cmp_eq_u32_sdwa s[8:9], v2, v2 src0_sel:WORD_0 src1_sel:WORD_1
    s_lshl_b32 s47, s44, 2
    s_add_u32 s47, s47, s48
    s_add_u32 s52, s47, 508
    s_sub_u32 s54, s48, 8
    s_mov_b32 s10, s44
    s_mov_b32 s11, 0
    v_lshlrev_b32 v1, 3, v0
    v_sub_u32 v13, s52, v1
    v_add_u32 v1, -512, v13
    v_max_i32 v14, s54, v1
    s_lshl_b32 s47, s46, 2
    s_add_u32 s47, s47, 86016
    v_mov_b32 v15, s47
    v_mov_b32 v16, 1
    v_mov_b32 v17, 2
    v_mov_b32 v18, 86016
    s_mul_i32 s47, s46, 14416
    s_add_u32 s47, s47, 104832
    s_sub_u32 s47, s47, s45
    v_add_u32 v8, s47, v29
    s_mov_b32 vcc_lo, 0x22222222
    s_mov_b32 vcc_hi, vcc_lo
    s_mov_b32 s52, 0x33333333
    s_mov_b32 s53, s52
    s_waitcnt vmcnt(8)
    s_barrier
    ds_read2_b64 v[96:99], v110 offset0:0 offset1:132
    ds_read2_b64 v[100:103], v110 offset0:16 offset1:148
    s_waitcnt lgkmcnt(1)
    global_store_dwordx4 v108, v[96:99], s[36:37] sc1
    s_waitcnt lgkmcnt(0)
    global_store_dwordx4 v108, v[100:103], s[36:37] offset:1024 sc1
    s_setprio 1
    s_waitcnt vmcnt(3)
KG:
    v_mul_f32 v4, s64, v4
    v_exp_f32 v4, v4
    s_nop 0
    v_cvt_pk_bf16_f32 v4, v4, v4
    v_and_b32 v4, s56, v4
    ds_read_b64 v[112:113], v18 offset:24
    v_pk_mul_f32 v[92:93], v[52:53], v[4:5] op_sel:[0,0] op_sel_hi:[1,0]
    v_pk_mul_f32 v[72:73], v[72:73], v[4:5] op_sel:[0,0] op_sel_hi:[1,0]
    v_pk_mul_f32 v[80:81], v[92:93], s[64:65]
    v_pk_mul_f32 v[70:71], v[72:73], v[94:95] op_sel:[0,0] op_sel_hi:[1,0]
    v_fract_f32 v81, v81
    v_exp_f32 v80, v80
    v_cos_f32 v52, v81
    v_sin_f32 v53, v81
    v_pk_fma_f32 v[70:71], v[72:73], v[94:95], v[70:71] op_sel:[1,1,0] op_sel_hi:[0,1,1] neg_lo:[1,0,0]
    v_pk_mul_f32 v[52:53], v[52:53], v[80:81] op_sel:[0,0] op_sel_hi:[1,0]
    v_cvt_pk_bf16_f32 v88, v70, -v71
    v_pk_mul_f32 v[58:59], v[52:53], v[52:53] op_sel:[0,0] op_sel_hi:[1,0]
    s_waitcnt lgkmcnt(0)
    v_readfirstlane_b32 s47, v112
    s_nop 0
    s_cmp_lg_u32 s47, 0
    s_cbranch_scc1 C_n_g
    s_mov_b32 s57, 4000000
C_n_w:
    ds_read_b64 v[112:113], v18 offset:24
    s_waitcnt lgkmcnt(0)
    v_readfirstlane_b32 s47, v112
    s_nop 0
    s_cmp_lg_u32 s47, 0
    s_cbranch_scc1 C_n_g
    s_sleep 0
    s_sub_u32 s57, s57, 1
    s_cmp_lg_u32 s57, 0
    s_cbranch_scc1 C_n_w
C_n_g:
    v_lshlrev_b32 v106, 1, v113
    v_dot2_u32_u16 v104, v96, s72, v106
    v_dot2_u32_u16 v105, v100, s72, v106
    v_dot2_u32_u16 v104, v97, s73, v104
    v_dot2_u32_u16 v105, v101, s73, v105
    v_dot2_u32_u16 v104, v98, s74, v104
    v_dot2_u32_u16 v105, v102, s74, v105
    v_dot2_u32_u16 v104, v99, s75, v104
    v_dot2_u32_u16 v105, v103, s75, v105
    s_nop 1
    v_alignbit_b32 v104, v104, v104, v107
    v_alignbit_b32 v105, v105, v105, v107
    s_nop 0
    v_add_u32_dpp v104, v104, v104 quad_perm:[1,0,3,2] row_mask:0xf bank_mask:0xf
    v_add_u32_dpp v105, v105, v105 quad_perm:[1,0,3,2] row_mask:0xf bank_mask:0xf
    s_nop 0
    v_add_u32_dpp v104, v104, v104 quad_perm:[2,3,0,1] row_mask:0xf bank_mask:0xf
    v_add_u32_dpp v105, v105, v105 quad_perm:[2,3,0,1] row_mask:0xf bank_mask:0xf
    v_cndmask_b32 v104, v104, v105, vcc
    s_mov_b64 exec, s[52:53]
    global_store_dword v109, v104, s[36:37] sc1
    s_mov_b64 exec, -1
    ds_write_addtid_b32 v88 offset:5712
    v_pk_fma_f32 v[58:59], v[52:53], v[52:53], v[58:59] op_sel:[1,1,0] op_sel_hi:[0,1,1] neg_lo:[1,0,0]
    v_pk_mul_f32 v[82:83], v[92:93], s[66:67]
    v_pk_mul_f32 v[62:63], v[58:59], v[58:59] op_sel:[0,0] op_sel_hi:[1,0]
    v_fract_f32 v83, v83
    v_pk_fma_f32 v[62:63], v[58:59], v[58:59], v[62:63] op_sel:[1,1,0] op_sel_hi:[0,1,1] neg_lo:[1,0,0]
    v_exp_f32 v82, v82
    v_pk_mul_f32 v[54:55], v[62:63], v[62:63] op_sel:[0,0] op_sel_hi:[1,0]
    v_cos_f32 v56, v83
    v_pk_fma_f32 v[54:55], v[62:63], v[62:63], v[54:55] op_sel:[1,1,0] op_sel_hi:[0,1,1] neg_lo:[1,0,0]
    v_sin_f32 v57, v83
    v_pk_mul_f32 v[72:73], v[70:71], v[54:55] op_sel:[0,0] op_sel_hi:[1,0]
    v_pk_mul_f32 v[56:57], v[56:57], v[82:83] op_sel:[0,0] op_sel_hi:[1,0]
    v_pk_fma_f32 v[72:73], v[70:71], v[54:55], v[72:73] op_sel:[1,1,0] op_sel_hi:[0,1,1] neg_lo:[1,0,0]
    v_pk_mul_f32 v[78:79], v[56:57], v[56:57] op_sel:[0,0] op_sel_hi:[1,0]
    v_pk_mul_f32 v[70:71], v[72:73], v[54:55] op_sel:[0,0] op_sel_hi:[1,0]
    v_cvt_pk_bf16_f32 v89, v72, -v73
    v_pk_fma_f32 v[70:71], v[72:73], v[54:55], v[70:71] op_sel:[1,1,0] op_sel_hi:[0,1,1] neg_lo:[1,0,0]
    ds_write_addtid_b32 v89 offset:5984
    v_pk_mul_f32 v[72:73], v[70:71], v[54:55] op_sel:[0,0] op_sel_hi:[1,0]
    v_cvt_pk_bf16_f32 v90, v70, -v71
    v_pk_fma_f32 v[72:73], v[70:71], v[54:55], v[72:73] op_sel:[1,1,0] op_sel_hi:[0,1,1] neg_lo:[1,0,0]
    ds_write_addtid_b32 v90 offset:6256
    v_pk_mul_f32 v[70:71], v[72:73], v[54:55] op_sel:[0,0] op_sel_hi:[1,0]
    v_cvt_pk_bf16_f32 v91, v72, -v73
    v_pk_fma_f32 v[70:71], v[72:73], v[54:55], v[70:71] op_sel:[1,1,0] op_sel_hi:[0,1,1] neg_lo:[1,0,0]
    ds_write_addtid_b32 v91 offset:6528
    v_pk_mul_f32 v[72:73], v[70:71], v[54:55] op_sel:[0,0] op_sel_hi:[1,0]
    v_cvt_pk_bf16_f32 v88, v70, -v71
    v_pk_fma_f32 v[72:73], v[70:71], v[54:55], v[72:73] op_sel:[1,1,0] op_sel_hi:[0,1,1] neg_lo:[1,0,0]
    ds_write_addtid_b32 v88 offset:6800
    v_pk_mul_f32 v[70:71], v[72:73], v[54:55] op_sel:[0,0] op_sel_hi:[1,0]
    v_cvt_pk_bf16_f32 v89, v72, -v73
    v_pk_fma_f32 v[70:71], v[72:73], v[54:55], v[70:71] op_sel:[1,1,0] op_sel_hi:[0,1,1] neg_lo:[1,0,0]
    ds_write_addtid_b32 v89 offset:7072
    v_pk_mul_f32 v[72:73], v[70:71], v[54:55] op_sel:[0,0] op_sel_hi:[1,0]
    v_cvt_pk_bf16_f32 v90, v70, -v71
    v_pk_fma_f32 v[72:73], v[70:71], v[54:55], v[72:73] op_sel:[1,1,0] op_sel_hi:[0,1,1] neg_lo:[1,0,0]
    ds_write_addtid_b32 v90 offset:7344
    v_pk_mul_f32 v[70:71], v[72:73], v[54:55] op_sel:[0,0] op_sel_hi:[1,0]
    v_cvt_pk_bf16_f32 v91, v72, -v73
    v_pk_fma_f32 v[70:71], v[72:73], v[54:55], v[70:71] op_sel:[1,1,0] op_sel_hi:[0,1,1] neg_lo:[1,0,0]
    ds_write_addtid_b32 v91 offset:7616
    v_pk_mul_f32 v[72:73], v[70:71], v[54:55] op_sel:[0,0] op_sel_hi:[1,0]
    v_cvt_pk_bf16_f32 v88, v70, -v71
    v_pk_fma_f32 v[72:73], v[70:71], v[54:55], v[72:73] op_sel:[1,1,0] op_sel_hi:[0,1,1] neg_lo:[1,0,0]
    ds_write_addtid_b32 v88 offset:7888
    v_pk_mul_f32 v[70:71], v[72:73], v[54:55] op_sel:[0,0] op_sel_hi:[1,0]
    v_cvt_pk_bf16_f32 v89, v72, -v73
    v_pk_fma_f32 v[70:71], v[72:73], v[54:55], v[70:71] op_sel:[1,1,0] op_sel_hi:[0,1,1] neg_lo:[1,0,0]
    ds_write_addtid_b32 v89 offset:8160
    v_pk_mul_f32 v[72:73], v[70:71], v[54:55] op_sel:[0,0] op_sel_hi:[1,0]
    v_cvt_pk_bf16_f32 v90, v70, -v71
    v_pk_fma_f32 v[72:73], v[70:71], v[54:55], v[72:73] op_sel:[1,1,0] op_sel_hi:[0,1,1] neg_lo:[1,0,0]
    ds_write_addtid_b32 v90 offset:8432
    v_pk_mul_f32 v[70:71], v[72:73], v[54:55] op_sel:[0,0] op_sel_hi:[1,0]
    v_cvt_pk_bf16_f32 v91, v72, -v73
    v_pk_fma_f32 v[70:71], v[72:73], v[54:55], v[70:71] op_sel:[1,1,0] op_sel_hi:[0,1,1] neg_lo:[1,0,0]
    ds_write_addtid_b32 v91 offset:8704
    v_pk_mul_f32 v[72:73], v[70:71], v[54:55] op_sel:[0,0] op_sel_hi:[1,0]
    v_cvt_pk_bf16_f32 v88, v70, -v71
    v_pk_fma_f32 v[72:73], v[70:71], v[54:55], v[72:73] op_sel:[1,1,0] op_sel_hi:[0,1,1] neg_lo:[1,0,0]
    ds_write_addtid_b32 v88 offset:8976
    v_pk_mul_f32 v[70:71], v[72:73], v[54:55] op_sel:[0,0] op_sel_hi:[1,0]
    v_cvt_pk_bf16_f32 v89, v72, -v73
    v_pk_fma_f32 v[70:71], v[72:73], v[54:55], v[70:71] op_sel:[1,1,0] op_sel_hi:[0,1,1] neg_lo:[1,0,0]
    ds_write_addtid_b32 v89 offset:9248
    v_pk_mul_f32 v[72:73], v[70:71], v[54:55] op_sel:[0,0] op_sel_hi:[1,0]
    v_cvt_pk_bf16_f32 v90, v70, -v71
    v_pk_fma_f32 v[72:73], v[70:71], v[54:55], v[72:73] op_sel:[1,1,0] op_sel_hi:[0,1,1] neg_lo:[1,0,0]
    ds_write_addtid_b32 v90 offset:9520
    v_pk_mul_f32 v[70:71], v[72:73], v[54:55] op_sel:[0,0] op_sel_hi:[1,0]
    v_cvt_pk_bf16_f32 v91, v72, -v73
    v_pk_fma_f32 v[70:71], v[72:73], v[54:55], v[70:71] op_sel:[1,1,0] op_sel_hi:[0,1,1] neg_lo:[1,0,0]
    ds_write_addtid_b32 v91 offset:9792
    v_pk_mul_f32 v[72:73], v[70:71], v[54:55] op_sel:[0,0] op_sel_hi:[1,0]
    v_cvt_pk_bf16_f32 v88, v70, -v71
    v_pk_fma_f32 v[72:73], v[70:71], v[54:55], v[72:73] op_sel:[1,1,0] op_sel_hi:[0,1,1] neg_lo:[1,0,0]
    ds_write_addtid_b32 v88 offset:10064
    v_pk_mul_f32 v[70:71], v[72:73], v[54:55] op_sel:[0,0] op_sel_hi:[1,0]
    v_cvt_pk_bf16_f32 v89, v72, -v73
    v_pk_fma_f32 v[70:71], v[72:73], v[54:55], v[70:71] op_sel:[1,1,0] op_sel_hi:[0,1,1] neg_lo:[1,0,0]
    ds_write_addtid_b32 v89 offset:10336
    v_pk_mul_f32 v[72:73], v[70:71], v[54:55] op_sel:[0,0] op_sel_hi:[1,0]
    v_cvt_pk_bf16_f32 v90, v70, -v71
    v_pk_fma_f32 v[72:73], v[70:71], v[54:55], v[72:73] op_sel:[1,1,0] op_sel_hi:[0,1,1] neg_lo:[1,0,0]
    ds_write_addtid_b32 v90 offset:10608
    v_pk_mul_f32 v[70:71], v[72:73], v[54:55] op_sel:[0,0] op_sel_hi:[1,0]
    v_cvt_pk_bf16_f32 v91, v72, -v73
    v_pk_fma_f32 v[70:71], v[72:73], v[54:55], v[70:71] op_sel:[1,1,0] op_sel_hi:[0,1,1] neg_lo:[1,0,0]
    ds_write_addtid_b32 v91 offset:10880
    v_pk_mul_f32 v[72:73], v[70:71], v[54:55] op_sel:[0,0] op_sel_hi:[1,0]
    v_cvt_pk_bf16_f32 v88, v70, -v71
    v_pk_fma_f32 v[72:73], v[70:71], v[54:55], v[72:73] op_sel:[1,1,0] op_sel_hi:[0,1,1] neg_lo:[1,0,0]
    v_pk_mul_f32 v[64:65], v[62:63], v[52:53] op_sel:[0,0] op_sel_hi:[1,0]
    v_pk_mul_f32 v[70:71], v[72:73], v[54:55] op_sel:[0,0] op_sel_hi:[1,0]
    v_cvt_pk_bf16_f32 v89, v72, -v73
    v_pk_fma_f32 v[70:71], v[72:73], v[54:55], v[70:71] op_sel:[1,1,0] op_sel_hi:[0,1,1] neg_lo:[1,0,0]
    v_pk_mul_f32 v[60:61], v[58:59], v[52:53] op_sel:[0,0] op_sel_hi:[1,0]
    v_pk_mul_f32 v[72:73], v[70:71], v[54:55] op_sel:[0,0] op_sel_hi:[1,0]
    v_cvt_pk_bf16_f32 v90, v70, -v71
    v_pk_fma_f32 v[72:73], v[70:71], v[54:55], v[72:73] op_sel:[1,1,0] op_sel_hi:[0,1,1] neg_lo:[1,0,0]
    v_pk_mul_f32 v[66:67], v[62:63], v[58:59] op_sel:[0,0] op_sel_hi:[1,0]
    v_pk_mul_f32 v[70:71], v[72:73], v[54:55] op_sel:[0,0] op_sel_hi:[1,0]
    v_cvt_pk_bf16_f32 v91, v72, -v73
    v_pk_fma_f32 v[70:71], v[72:73], v[54:55], v[70:71] op_sel:[1,1,0] op_sel_hi:[0,1,1] neg_lo:[1,0,0]
    v_pk_fma_f32 v[78:79], v[56:57], v[56:57], v[78:79] op_sel:[1,1,0] op_sel_hi:[0,1,1] neg_lo:[1,0,0]
    v_pk_mul_f32 v[72:73], v[70:71], v[54:55] op_sel:[0,0] op_sel_hi:[1,0]
    ds_write_addtid_b32 v88 offset:11152
    v_pk_fma_f32 v[72:73], v[70:71], v[54:55], v[72:73] op_sel:[1,1,0] op_sel_hi:[0,1,1] neg_lo:[1,0,0]
    v_cvt_pk_bf16_f32 v84, v52, v53
    v_pk_fma_f32 v[64:65], v[62:63], v[52:53], v[64:65] op_sel:[1,1,0] op_sel_hi:[0,1,1] neg_lo:[1,0,0]
    v_pk_mul_f32 v[80:81], v[56:57], v[58:59] op_sel:[0,0] op_sel_hi:[1,0]
    v_cvt_pk_bf16_f32 v88, v70, -v71
    ds_write_addtid_b32 v84 offset:272
    v_cvt_pk_bf16_f32 v85, v58, v59
    v_pk_fma_f32 v[60:61], v[58:59], v[52:53], v[60:61] op_sel:[1,1,0] op_sel_hi:[0,1,1] neg_lo:[1,0,0]
    v_pk_fma_f32 v[66:67], v[62:63], v[58:59], v[66:67] op_sel:[1,1,0] op_sel_hi:[0,1,1] neg_lo:[1,0,0]
    v_pk_mul_f32 v[82:83], v[56:57], v[62:63] op_sel:[0,0] op_sel_hi:[1,0]
    v_pk_mul_f32 v[74:75], v[78:79], v[56:57] op_sel:[0,0] op_sel_hi:[1,0]
    v_pk_mul_f32 v[70:71], v[72:73], v[54:55] op_sel:[0,0] op_sel_hi:[1,0]
    ds_write_addtid_b32 v85 offset:544
    v_cvt_pk_bf16_f32 v84, v64, v65
    v_pk_fma_f32 v[80:81], v[56:57], v[58:59], v[80:81] op_sel:[1,1,0] op_sel_hi:[0,1,1] neg_lo:[1,0,0]
    ds_write_addtid_b32 v84 offset:1360
    v_cvt_pk_bf16_f32 v85, v66, v67
    v_pk_mul_f32 v[68:69], v[62:63], v[60:61] op_sel:[0,0] op_sel_hi:[1,0]
    v_pk_fma_f32 v[82:83], v[56:57], v[62:63], v[82:83] op_sel:[1,1,0] op_sel_hi:[0,1,1] neg_lo:[1,0,0]
    v_pk_fma_f32 v[74:75], v[78:79], v[56:57], v[74:75] op_sel:[1,1,0] op_sel_hi:[0,1,1] neg_lo:[1,0,0]
    ds_write_addtid_b32 v89 offset:11424
    v_pk_fma_f32 v[70:71], v[72:73], v[54:55], v[70:71] op_sel:[1,1,0] op_sel_hi:[0,1,1] neg_lo:[1,0,0]
    v_cvt_pk_bf16_f32 v87, v60, v61
    ds_write_addtid_b32 v85 offset:1632
    v_cvt_pk_bf16_f32 v84, v80, v81
    v_cvt_pk_bf16_f32 v89, v72, -v73
    v_cvt_pk_bf16_f32 v86, v62, v63
    ds_write_addtid_b32 v87 offset:816
    v_pk_fma_f32 v[68:69], v[62:63], v[60:61], v[68:69] op_sel:[1,1,0] op_sel_hi:[0,1,1] neg_lo:[1,0,0]
    v_cvt_pk_bf16_f32 v85, v82, v83
    v_pk_mul_f32 v[80:81], v[56:57], v[66:67] op_sel:[0,0] op_sel_hi:[1,0]
    v_pk_mul_f32 v[76:77], v[74:75], v[56:57] op_sel:[0,0] op_sel_hi:[1,0]
    v_pk_mul_f32 v[72:73], v[70:71], v[54:55] op_sel:[0,0] op_sel_hi:[1,0]
    ds_write_addtid_b32 v86 offset:1088
    v_cvt_pk_bf16_f32 v87, v56, v57
    v_pk_mul_f32 v[82:83], v[78:79], v[62:63] op_sel:[0,0] op_sel_hi:[1,0]
    v_cvt_pk_bf16_f32 v86, v68, v69
    ds_write_addtid_b32 v87 offset:2176
    v_pk_fma_f32 v[80:81], v[56:57], v[66:67], v[80:81] op_sel:[1,1,0] op_sel_hi:[0,1,1] neg_lo:[1,0,0]
    ds_write_addtid_b32 v90 offset:11696
    v_pk_fma_f32 v[76:77], v[74:75], v[56:57], v[76:77] op_sel:[1,1,0] op_sel_hi:[0,1,1] neg_lo:[1,0,0]
    v_pk_fma_f32 v[72:73], v[70:71], v[54:55], v[72:73] op_sel:[1,1,0] op_sel_hi:[0,1,1] neg_lo:[1,0,0]
    ds_write_addtid_b32 v86 offset:1904
    v_cvt_pk_bf16_f32 v87, v78, v79
    v_pk_fma_f32 v[82:83], v[78:79], v[62:63], v[82:83] op_sel:[1,1,0] op_sel_hi:[0,1,1] neg_lo:[1,0,0]
    v_cvt_pk_bf16_f32 v90, v70, -v71
    v_cvt_pk_bf16_f32 v86, v80, v81
    v_pk_mul_f32 v[78:79], v[76:77], v[56:57] op_sel:[0,0] op_sel_hi:[1,0]
    v_pk_mul_f32 v[70:71], v[72:73], v[54:55] op_sel:[0,0] op_sel_hi:[1,0]
    v_pk_mul_f32 v[80:81], v[74:75], v[62:63] op_sel:[0,0] op_sel_hi:[1,0]
    ds_write_addtid_b32 v85 offset:2720
    ds_write_addtid_b32 v91 offset:11968
    v_pk_fma_f32 v[78:79], v[76:77], v[56:57], v[78:79] op_sel:[1,1,0] op_sel_hi:[0,1,1] neg_lo:[1,0,0]
    v_pk_fma_f32 v[70:71], v[72:73], v[54:55], v[70:71] op_sel:[1,1,0] op_sel_hi:[0,1,1] neg_lo:[1,0,0]
    v_cvt_pk_bf16_f32 v85, v74, v75
    v_pk_fma_f32 v[80:81], v[74:75], v[62:63], v[80:81] op_sel:[1,1,0] op_sel_hi:[0,1,1] neg_lo:[1,0,0]
    v_cvt_pk_bf16_f32 v91, v72, -v73
    v_pk_mul_f32 v[74:75], v[78:79], v[56:57] op_sel:[0,0] op_sel_hi:[1,0]
    v_pk_mul_f32 v[72:73], v[70:71], v[54:55] op_sel:[0,0] op_sel_hi:[1,0]
    ds_write_addtid_b32 v87 offset:3264
    ds_write_addtid_b32 v88 offset:12240
    v_pk_fma_f32 v[74:75], v[78:79], v[56:57], v[74:75] op_sel:[1,1,0] op_sel_hi:[0,1,1] neg_lo:[1,0,0]
    v_pk_fma_f32 v[72:73], v[70:71], v[54:55], v[72:73] op_sel:[1,1,0] op_sel_hi:[0,1,1] neg_lo:[1,0,0]
    v_cvt_pk_bf16_f32 v87, v76, v77
    v_cvt_pk_bf16_f32 v88, v70, -v71
    ds_write_addtid_b32 v84 offset:2448
    v_pk_mul_f32 v[76:77], v[74:75], v[56:57] op_sel:[0,0] op_sel_hi:[1,0]
    v_pk_mul_f32 v[70:71], v[72:73], v[54:55] op_sel:[0,0] op_sel_hi:[1,0]
    v_cvt_pk_bf16_f32 v84, v82, v83
    ds_write_addtid_b32 v84 offset:3536
    ds_write_addtid_b32 v89 offset:12512
    v_pk_fma_f32 v[76:77], v[74:75], v[56:57], v[76:77] op_sel:[1,1,0] op_sel_hi:[0,1,1] neg_lo:[1,0,0]
    v_pk_fma_f32 v[70:71], v[72:73], v[54:55], v[70:71] op_sel:[1,1,0] op_sel_hi:[0,1,1] neg_lo:[1,0,0]
    v_cvt_pk_bf16_f32 v84, v78, v79
    v_cvt_pk_bf16_f32 v89, v72, -v73
    v_pk_mul_f32 v[78:79], v[76:77], v[56:57] op_sel:[0,0] op_sel_hi:[1,0]
    v_pk_mul_f32 v[72:73], v[70:71], v[54:55] op_sel:[0,0] op_sel_hi:[1,0]
    ds_write_addtid_b32 v86 offset:2992
    v_cvt_pk_bf16_f32 v86, v80, v81
    v_pk_fma_f32 v[78:79], v[76:77], v[56:57], v[78:79] op_sel:[1,1,0] op_sel_hi:[0,1,1] neg_lo:[1,0,0]
    v_pk_fma_f32 v[72:73], v[70:71], v[54:55], v[72:73] op_sel:[1,1,0] op_sel_hi:[0,1,1] neg_lo:[1,0,0]
    ds_write_addtid_b32 v85 offset:3808
    ds_write_addtid_b32 v86 offset:4080
    ds_write_addtid_b32 v87 offset:4352
    ds_write_addtid_b32 v90 offset:12784
    ds_write_addtid_b32 v91 offset:13056
    v_cvt_pk_bf16_f32 v85, v74, v75
    v_cvt_pk_bf16_f32 v86, v76, v77
    v_cvt_pk_bf16_f32 v90, v70, -v71
    v_cvt_pk_bf16_f32 v87, v78, v79
    v_cvt_pk_bf16_f32 v91, v72, -v73
    ds_write_addtid_b32 v84 offset:4624
    ds_write_addtid_b32 v85 offset:4896
    ds_write_addtid_b32 v88 offset:13328
    ds_write_addtid_b32 v86 offset:5168
    ds_write_addtid_b32 v89 offset:13600
    ds_write_addtid_b32 v90 offset:13872
    ds_write_addtid_b32 v87 offset:5440
    ds_write_addtid_b32 v91 offset:14144
    ds_read_b128 v[96:99], v29 offset:0
    ds_read_b128 v[100:103], v29 offset:5712
    ds_read_b128 v[104:107], v29 offset:32
    ds_read_b128 v[108:111], v29 offset:5744
    ds_read_b128 v[112:115], v29 offset:64
    ds_read_b128 v[116:119], v29 offset:5776
    ds_read_b128 v[120:123], v29 offset:96
    ds_read_b128 v[124:127], v29 offset:5808
    ds_read_b128 v[128:131], v29 offset:128
    ds_read_b128 v[132:135], v29 offset:5840
    ds_read_b128 v[136:139], v29 offset:160
    ds_read_b128 v[140:143], v29 offset:5872
    v_mov_b64 v[2:3], 0
    v_mov_b32 v1, s54
    s_waitcnt vmcnt(0)
    s_barrier
    ds_read_b128 v[144:147], v29 offset:192
    ds_read_b128 v[148:151], v29 offset:5904
    s_waitcnt lgkmcnt(12)
    v_mfma_f32_32x32x16_bf16 v[36:51], v[96:99], v[100:103], 0
    ds_read_b128 v[152:155], v29 offset:224
    ds_read_b128 v[156:159], v29 offset:5936
    s_waitcnt lgkmcnt(12)
    v_mfma_f32_32x32x16_bf16 v[36:51], v[104:107], v[108:111], v[36:51]
    ds_read_b128 v[96:99], v8 offset:0
    ds_read_b128 v[100:103], v8 offset:5712
    s_waitcnt lgkmcnt(12)
    v_mfma_f32_32x32x16_bf16 v[36:51], v[112:115], v[116:119], v[36:51]
    ds_read_b128 v[104:107], v8 offset:32
    ds_read_b128 v[108:111], v8 offset:5744
    s_waitcnt lgkmcnt(12)
    v_mfma_f32_32x32x16_bf16 v[36:51], v[120:123], v[124:127], v[36:51]
    ds_read_b128 v[112:115], v8 offset:64
    ds_read_b128 v[116:119], v8 offset:5776
    s_waitcnt lgkmcnt(12)
    v_mfma_f32_32x32x16_bf16 v[36:51], v[128:131], v[132:135], v[36:51]
    ds_read_b128 v[120:123], v8 offset:96
    ds_read_b128 v[124:127], v8 offset:5808
    s_waitcnt lgkmcnt(12)
    v_mfma_f32_32x32x16_bf16 v[36:51], v[136:139], v[140:143], v[36:51]
    ds_read_b128 v[128:131], v8 offset:128
    ds_read_b128 v[132:135], v8 offset:5840
    s_waitcnt lgkmcnt(12)
    v_mfma_f32_32x32x16_bf16 v[36:51], v[144:147], v[148:151], v[36:51]
    ds_read_b128 v[136:139], v8 offset:160
    ds_read_b128 v[140:143], v8 offset:5872
    s_waitcnt lgkmcnt(12)
    v_mfma_f32_32x32x16_bf16 v[36:51], v[152:155], v[156:159], v[36:51]
    ds_read_b128 v[144:147], v8 offset:192
    ds_read_b128 v[148:151], v8 offset:5904
    s_waitcnt lgkmcnt(12)
    v_mfma_f32_32x32x16_bf16 v[36:51], v[96:99], v[100:103], v[36:51]
    ds_read_b128 v[152:155], v8 offset:224
    ds_read_b128 v[156:159], v8 offset:5936
    s_waitcnt lgkmcnt(12)
    v_mfma_f32_32x32x16_bf16 v[36:51], v[104:107], v[108:111], v[36:51]
    s_waitcnt lgkmcnt(10)
    v_mfma_f32_32x32x16_bf16 v[36:51], v[112:115], v[116:119], v[36:51]
    s_waitcnt lgkmcnt(8)
    v_mfma_f32_32x32x16_bf16 v[36:51], v[120:123], v[124:127], v[36:51]
    s_waitcnt lgkmcnt(6)
    v_mfma_f32_32x32x16_bf16 v[36:51], v[128:131], v[132:135], v[36:51]
    s_waitcnt lgkmcnt(4)
    v_mfma_f32_32x32x16_bf16 v[36:51], v[136:139], v[140:143], v[36:51]
    s_waitcnt lgkmcnt(2)
    v_mfma_f32_32x32x16_bf16 v[36:51], v[144:147], v[148:151], v[36:51]
    s_waitcnt lgkmcnt(0)
    v_mfma_f32_32x32x16_bf16 v[36:51], v[152:155], v[156:159], v[36:51]
    ds_write_b64 v1, v[2:3]
    s_waitcnt vmcnt(3)
    s_nop 9
    v_add_f32 v36, v36, v7
    ds_write_b128 v30, v[36:39]
    ds_write_b64 v31, v[40:41] offset:1024
    ds_write_b64 v32, v[42:43] offset:1032
    ds_read2_b32 v[128:129], v14 offset0:0 offset1:1
    ds_read2_b32 v[126:127], v13 offset0:0 offset1:1
    ds_read2_b32 v[124:125], v13 offset0:128 offset1:129
    ds_read2_b32 v[122:123], v12 offset0:0 offset1:1
    ds_write_b32 v33, v44 offset:2048
    ds_write_b32 v33, v45 offset:2176
    ds_write_b32 v33, v46 offset:2304
    ds_write_b32 v33, v47 offset:2432
    ds_write_b32 v15, v16 offset:32
    s_waitcnt lgkmcnt(7)
    v_cvt_pk_bf16_f32 v148, v129, v128
    ds_read2_b32 v[120:121], v12 offset0:64 offset1:65
    ds_write_addtid_b32 v148 offset:4096
    ds_write_addtid_b32 v148 offset:8580
    v_cvt_pk_bf16_f32 v147, v127, v126
    ds_read2_b32 v[118:119], v11 offset0:0 offset1:1
    ds_write_addtid_b32 v147 offset:3840
    ds_write_addtid_b32 v147 offset:8324
    s_waitcnt lgkmcnt(11)
    v_cndmask_b32 v125, v125, v124, s[10:11]
    v_cvt_pk_bf16_f32 v146, v125, v124
    ds_read2_b32 v[116:117], v11 offset0:32 offset1:33
    ds_write_addtid_b32 v146 offset:3584
    ds_write_addtid_b32 v146 offset:8068
    v_cndmask_b32 v122, v122, v123, s[8:9]
    v_cvt_pk_bf16_f32 v145, v123, v122
    ds_read2_b32 v[114:115], v11 offset0:64 offset1:65
    ds_write_addtid_b32 v145 offset:3328
    ds_write_addtid_b32 v145 offset:7812
    s_waitcnt lgkmcnt(8)
    v_cndmask_b32 v120, v120, v121, s[8:9]
    v_cvt_pk_bf16_f32 v144, v121, v120
    ds_read2_b32 v[112:113], v11 offset0:96 offset1:97
    ds_write_addtid_b32 v144 offset:3072
    ds_write_addtid_b32 v144 offset:7556
    v_cndmask_b32 v118, v118, v119, s[6:7]
    v_cvt_pk_bf16_f32 v143, v119, v118
    ds_read2_b32 v[110:111], v10 offset0:0 offset1:1
    ds_write_addtid_b32 v143 offset:2816
    ds_write_addtid_b32 v143 offset:7300
    s_waitcnt lgkmcnt(8)
    v_cndmask_b32 v116, v116, v117, s[6:7]
    v_cvt_pk_bf16_f32 v142, v117, v116
    ds_read2_b32 v[108:109], v10 offset0:16 offset1:17
    ds_write_addtid_b32 v142 offset:2560
    ds_write_addtid_b32 v142 offset:7044
    ds_read_b64 v[64:65], v20 offset:4032
    ds_read_b64 v[66:67], v20 offset:4040
    v_cndmask_b32 v114, v114, v115, s[6:7]
    v_cvt_pk_bf16_f32 v141, v115, v114
    ds_read2_b32 v[106:107], v10 offset0:32 offset1:33
    ds_write_addtid_b32 v141 offset:2304
    ds_write_addtid_b32 v141 offset:6788
    ds_read_b64 v[68:69], v20 offset:3008
    ds_read_b64 v[70:71], v20 offset:3016
    s_waitcnt lgkmcnt(12)
    v_cndmask_b32 v112, v112, v113, s[6:7]
    v_cvt_pk_bf16_f32 v140, v113, v112
    ds_read2_b32 v[104:105], v10 offset0:48 offset1:49
    ds_write_addtid_b32 v140 offset:2048
    ds_write_addtid_b32 v140 offset:6532
    ds_read_b64 v[88:89], v20 offset:3968
    ds_read_b64 v[90:91], v20 offset:3976
    v_cndmask_b32 v110, v110, v111, s[4:5]
    v_cvt_pk_bf16_f32 v139, v111, v110
    ds_read2_b32 v[102:103], v10 offset0:64 offset1:65
    ds_write_addtid_b32 v139 offset:1792
    ds_write_addtid_b32 v139 offset:6276
    ds_read_b64 v[92:93], v20 offset:2944
    ds_read_b64 v[94:95], v20 offset:2952
    s_waitcnt lgkmcnt(14)
    v_cndmask_b32 v108, v108, v109, s[4:5]
    v_cvt_pk_bf16_f32 v138, v109, v108
    ds_read2_b32 v[100:101], v10 offset0:80 offset1:81
    ds_write_addtid_b32 v138 offset:1536
    ds_write_addtid_b32 v138 offset:6020
    v_cndmask_b32 v106, v106, v107, s[4:5]
    v_cvt_pk_bf16_f32 v137, v107, v106
    ds_read2_b32 v[98:99], v10 offset0:96 offset1:97
    ds_write_addtid_b32 v137 offset:1280
    ds_write_addtid_b32 v137 offset:5764
    s_waitcnt lgkmcnt(10)
    v_cndmask_b32 v104, v104, v105, s[4:5]
    v_cvt_pk_bf16_f32 v136, v105, v104
    ds_read2_b32 v[96:97], v10 offset0:112 offset1:113
    ds_write_addtid_b32 v136 offset:1024
    ds_write_addtid_b32 v136 offset:5508
    ds_read_b128 v[4:7], v18 offset:48
    v_cndmask_b32 v102, v102, v103, s[4:5]
    v_cvt_pk_bf16_f32 v135, v103, v102
    ds_write_addtid_b32 v135 offset:768
    ds_write_addtid_b32 v135 offset:5252
    s_waitcnt lgkmcnt(8)
    v_cndmask_b32 v100, v100, v101, s[4:5]
    v_cvt_pk_bf16_f32 v134, v101, v100
    ds_write_addtid_b32 v134 offset:512
    ds_write_addtid_b32 v134 offset:4996
    v_cndmask_b32 v98, v98, v99, s[4:5]
    v_cvt_pk_bf16_f32 v133, v99, v98
    ds_write_addtid_b32 v133 offset:256
    ds_write_addtid_b32 v133 offset:4740
    s_waitcnt lgkmcnt(9)
    v_cndmask_b32 v96, v96, v97, s[4:5]
    v_cvt_pk_bf16_f32 v132, v97, v96
    ds_write_addtid_b32 v132 offset:0
    ds_write_addtid_b32 v132 offset:4484
    s_waitcnt lgkmcnt(8)
    v_min3_u32 v4, v4, v5, v6
    v_min_u32 v4, v4, v7
    s_nop 0
    v_readfirstlane_b32 s47, v4
    s_nop 0
    s_cmp_lg_u32 s47, 0
    s_cbranch_scc1 C_u_g
    s_mov_b32 s57, 4000000
C_u_w:
    ds_read_b128 v[4:7], v18 offset:48
    s_waitcnt lgkmcnt(0)
    v_min3_u32 v4, v4, v5, v6
    v_min_u32 v4, v4, v7
    s_nop 0
    v_readfirstlane_b32 s47, v4
    s_nop 0
    s_cmp_lg_u32 s47, 0
    s_cbranch_scc1 C_u_g
    s_sleep 0
    s_sub_u32 s57, s57, 1
    s_cmp_lg_u32 s57, 0
    s_cbranch_scc1 C_u_w
C_u_g:
    s_setprio 2
    ds_read_b128 v[72:75], v21 offset:960
    ds_read_b128 v[76:79], v21 offset:1984
    ds_read_b128 v[80:83], v21 offset:3008
    ds_read_b128 v[84:87], v21 offset:4032
    ds_read_b128 v[96:99], v22 offset:896
    ds_read_b128 v[100:103], v22 offset:1920
    ds_read_b128 v[104:107], v22 offset:2944
    ds_read_b128 v[108:111], v22 offset:3968
    s_waitcnt lgkmcnt(4)
    v_mfma_f32_16x16x32_bf16 v[48:51], v[64:67], v[72:75], 0
    ds_read_b64 v[112:113], v20 offset:3904
    ds_read_b64 v[114:115], v20 offset:3912
    v_mfma_f32_16x16x32_bf16 v[52:55], v[68:71], v[72:75], 0
    ds_read_b64 v[116:117], v20 offset:2880
    v_mfma_f32_16x16x32_bf16 v[52:55], v[64:67], v[76:79], v[52:55]
    ds_read_b64 v[118:119], v20 offset:2888
    v_mfma_f32_16x16x32_bf16 v[56:59], v[68:71], v[76:79], 0
    ds_read_b128 v[120:123], v23 offset:832
    v_mfma_f32_16x16x32_bf16 v[56:59], v[64:67], v[80:83], v[56:59]
    ds_read_b128 v[124:127], v23 offset:1856
    v_mfma_f32_16x16x32_bf16 v[60:63], v[68:71], v[80:83], 0
    ds_read_b128 v[128:131], v23 offset:2880
    v_mfma_f32_16x16x32_bf16 v[60:63], v[64:67], v[84:87], v[60:63]
    ds_read_b128 v[132:135], v23 offset:3904
    s_waitcnt lgkmcnt(8)
    v_mfma_f32_16x16x32_bf16 v[48:51], v[88:91], v[96:99], v[48:51]
    ds_read_b64 v[64:65], v20 offset:3840
    ds_read_b64 v[66:67], v20 offset:3848
    v_mfma_f32_16x16x32_bf16 v[52:55], v[92:95], v[96:99], v[52:55]
    ds_read_b64 v[68:69], v20 offset:2816
    v_mfma_f32_16x16x32_bf16 v[52:55], v[88:91], v[100:103], v[52:55]
    ds_read_b64 v[70:71], v20 offset:2824
    v_mfma_f32_16x16x32_bf16 v[56:59], v[92:95], v[100:103], v[56:59]
    ds_read_b128 v[72:75], v24 offset:768
    v_mfma_f32_16x16x32_bf16 v[56:59], v[88:91], v[104:107], v[56:59]
    ds_read_b128 v[76:79], v24 offset:1792
    v_mfma_f32_16x16x32_bf16 v[60:63], v[92:95], v[104:107], v[60:63]
    ds_read_b128 v[80:83], v24 offset:2816
    v_mfma_f32_16x16x32_bf16 v[60:63], v[88:91], v[108:111], v[60:63]
    ds_read_b128 v[84:87], v24 offset:3840
    s_waitcnt lgkmcnt(8)
    v_mfma_f32_16x16x32_bf16 v[48:51], v[112:115], v[120:123], v[48:51]
    ds_read_b64 v[88:89], v20 offset:3776
    ds_read_b64 v[90:91], v20 offset:3784
    v_mfma_f32_16x16x32_bf16 v[52:55], v[116:119], v[120:123], v[52:55]
    ds_read_b64 v[92:93], v20 offset:2752
    v_mfma_f32_16x16x32_bf16 v[52:55], v[112:115], v[124:127], v[52:55]
    ds_read_b64 v[94:95], v20 offset:2760
    v_mfma_f32_16x16x32_bf16 v[56:59], v[116:119], v[124:127], v[56:59]
    ds_read_b128 v[96:99], v25 offset:704
    v_mfma_f32_16x16x32_bf16 v[56:59], v[112:115], v[128:131], v[56:59]
    ds_read_b128 v[100:103], v25 offset:1728
    v_mfma_f32_16x16x32_bf16 v[60:63], v[116:119], v[128:131], v[60:63]
    ds_read_b128 v[104:107], v25 offset:2752
    v_mfma_f32_16x16x32_bf16 v[60:63], v[112:115], v[132:135], v[60:63]
    ds_read_b128 v[108:111], v25 offset:3776
    s_waitcnt lgkmcnt(8)
    v_mfma_f32_16x16x32_bf16 v[48:51], v[64:67], v[72:75], v[48:51]
    ds_read_b64 v[112:113], v20 offset:3712
    ds_read_b64 v[114:115], v20 offset:3720
    v_mfma_f32_16x16x32_bf16 v[52:55], v[68:71], v[72:75], v[52:55]
    ds_read_b64 v[116:117], v20 offset:2688
    v_mfma_f32_16x16x32_bf16 v[52:55], v[64:67], v[76:79], v[52:55]
    ds_read_b64 v[118:119], v20 offset:2696
    v_mfma_f32_16x16x32_bf16 v[56:59], v[68:71], v[76:79], v[56:59]
    ds_read_b128 v[120:123], v26 offset:640
    v_mfma_f32_16x16x32_bf16 v[56:59], v[64:67], v[80:83], v[56:59]
    ds_read_b128 v[124:127], v26 offset:1664
    v_mfma_f32_16x16x32_bf16 v[60:63], v[68:71], v[80:83], v[60:63]
    ds_read_b128 v[128:131], v26 offset:2688
    v_mfma_f32_16x16x32_bf16 v[60:63], v[64:67], v[84:87], v[60:63]
    ds_read_b128 v[132:135], v26 offset:3712
    s_waitcnt lgkmcnt(8)
    v_mfma_f32_16x16x32_bf16 v[48:51], v[88:91], v[96:99], v[48:51]
    ds_read_b64 v[64:65], v20 offset:3648
    ds_read_b64 v[66:67], v20 offset:3656
    v_mfma_f32_16x16x32_bf16 v[52:55], v[92:95], v[96:99], v[52:55]
    ds_read_b64 v[68:69], v20 offset:2624
    v_mfma_f32_16x16x32_bf16 v[52:55], v[88:91], v[100:103], v[52:55]
    ds_read_b64 v[70:71], v20 offset:2632
    v_mfma_f32_16x16x32_bf16 v[56:59], v[92:95], v[100:103], v[56:59]
    ds_read_b128 v[72:75], v27 offset:576
    v_mfma_f32_16x16x32_bf16 v[56:59], v[88:91], v[104:107], v[56:59]
    ds_read_b128 v[76:79], v27 offset:1600
    v_mfma_f32_16x16x32_bf16 v[60:63], v[92:95], v[104:107], v[60:63]
    ds_read_b128 v[80:83], v27 offset:2624
    v_mfma_f32_16x16x32_bf16 v[60:63], v[88:91], v[108:111], v[60:63]
    ds_read_b128 v[84:87], v27 offset:3648
    s_waitcnt lgkmcnt(8)
    v_mfma_f32_16x16x32_bf16 v[48:51], v[112:115], v[120:123], v[48:51]
    ds_read_b64 v[88:89], v20 offset:3584
    ds_read_b64 v[90:91], v20 offset:3592
    v_mfma_f32_16x16x32_bf16 v[52:55], v[116:119], v[120:123], v[52:55]
    ds_read_b64 v[92:93], v20 offset:2560
    v_mfma_f32_16x16x32_bf16 v[52:55], v[112:115], v[124:127], v[52:55]
    ds_read_b64 v[94:95], v20 offset:2568
    v_mfma_f32_16x16x32_bf16 v[56:59], v[116:119], v[124:127], v[56:59]
    ds_read_b128 v[96:99], v28 offset:512
    v_mfma_f32_16x16x32_bf16 v[56:59], v[112:115], v[128:131], v[56:59]
    ds_read_b128 v[100:103], v28 offset:1536
    v_mfma_f32_16x16x32_bf16 v[60:63], v[116:119], v[128:131], v[60:63]
    ds_read_b128 v[104:107], v28 offset:2560
    v_mfma_f32_16x16x32_bf16 v[60:63], v[112:115], v[132:135], v[60:63]
    ds_read_b128 v[108:111], v28 offset:3584
    s_waitcnt lgkmcnt(8)
    v_mfma_f32_16x16x32_bf16 v[48:51], v[64:67], v[72:75], v[48:51]
    ds_read_b64 v[112:113], v20 offset:3520
    ds_read_b64 v[114:115], v20 offset:3528
    v_mfma_f32_16x16x32_bf16 v[52:55], v[68:71], v[72:75], v[52:55]
    ds_read_b64 v[116:117], v20 offset:2496
    v_mfma_f32_16x16x32_bf16 v[52:55], v[64:67], v[76:79], v[52:55]
    ds_read_b64 v[118:119], v20 offset:2504
    v_mfma_f32_16x16x32_bf16 v[56:59], v[68:71], v[76:79], v[56:59]
    ds_read_b128 v[120:123], v21 offset:448
    v_mfma_f32_16x16x32_bf16 v[56:59], v[64:67], v[80:83], v[56:59]
    ds_read_b128 v[124:127], v21 offset:1472
    v_mfma_f32_16x16x32_bf16 v[60:63], v[68:71], v[80:83], v[60:63]
    ds_read_b128 v[128:131], v21 offset:2496
    v_mfma_f32_16x16x32_bf16 v[60:63], v[64:67], v[84:87], v[60:63]
    ds_read_b128 v[132:135], v21 offset:3520
    s_waitcnt lgkmcnt(8)
    v_mfma_f32_16x16x32_bf16 v[48:51], v[88:91], v[96:99], v[48:51]
    ds_read_b64 v[64:65], v20 offset:3456
    ds_read_b64 v[66:67], v20 offset:3464
    v_mfma_f32_16x16x32_bf16 v[52:55], v[92:95], v[96:99], v[52:55]
    ds_read_b64 v[68:69], v20 offset:2432
    v_mfma_f32_16x16x32_bf16 v[52:55], v[88:91], v[100:103], v[52:55]
    ds_read_b64 v[70:71], v20 offset:2440
    v_mfma_f32_16x16x32_bf16 v[56:59], v[92:95], v[100:103], v[56:59]
    ds_read_b128 v[72:75], v22 offset:384
    v_mfma_f32_16x16x32_bf16 v[56:59], v[88:91], v[104:107], v[56:59]
    ds_read_b128 v[76:79], v22 offset:1408
    v_mfma_f32_16x16x32_bf16 v[60:63], v[92:95], v[104:107], v[60:63]
    ds_read_b128 v[80:83], v22 offset:2432
    v_mfma_f32_16x16x32_bf16 v[60:63], v[88:91], v[108:111], v[60:63]
    ds_read_b128 v[84:87], v22 offset:3456
    s_waitcnt lgkmcnt(8)
    v_mfma_f32_16x16x32_bf16 v[48:51], v[112:115], v[120:123], v[48:51]
    ds_read_b64 v[88:89], v20 offset:3392
    ds_read_b64 v[90:91], v20 offset:3400
    v_mfma_f32_16x16x32_bf16 v[52:55], v[116:119], v[120:123], v[52:55]
    ds_read_b64 v[92:93], v20 offset:2368
    v_mfma_f32_16x16x32_bf16 v[52:55], v[112:115], v[124:127], v[52:55]
    ds_read_b64 v[94:95], v20 offset:2376
    v_mfma_f32_16x16x32_bf16 v[56:59], v[116:119], v[124:127], v[56:59]
    ds_read_b128 v[96:99], v23 offset:320
    v_mfma_f32_16x16x32_bf16 v[56:59], v[112:115], v[128:131], v[56:59]
    ds_read_b128 v[100:103], v23 offset:1344
    v_mfma_f32_16x16x32_bf16 v[60:63], v[116:119], v[128:131], v[60:63]
    ds_read_b128 v[104:107], v23 offset:2368
    v_mfma_f32_16x16x32_bf16 v[60:63], v[112:115], v[132:135], v[60:63]
    ds_read_b128 v[108:111], v23 offset:3392
    s_waitcnt lgkmcnt(8)
    v_mfma_f32_16x16x32_bf16 v[48:51], v[64:67], v[72:75], v[48:51]
    ds_read_b64 v[112:113], v20 offset:3328
    ds_read_b64 v[114:115], v20 offset:3336
    v_mfma_f32_16x16x32_bf16 v[52:55], v[68:71], v[72:75], v[52:55]
    ds_read_b64 v[116:117], v20 offset:2304
    v_mfma_f32_16x16x32_bf16 v[52:55], v[64:67], v[76:79], v[52:55]
    ds_read_b64 v[118:119], v20 offset:2312
    v_mfma_f32_16x16x32_bf16 v[56:59], v[68:71], v[76:79], v[56:59]
    ds_read_b128 v[120:123], v24 offset:256
    v_mfma_f32_16x16x32_bf16 v[56:59], v[64:67], v[80:83], v[56:59]
    ds_read_b128 v[124:127], v24 offset:1280
    v_mfma_f32_16x16x32_bf16 v[60:63], v[68:71], v[80:83], v[60:63]
    ds_read_b128 v[128:131], v24 offset:2304
    v_mfma_f32_16x16x32_bf16 v[60:63], v[64:67], v[84:87], v[60:63]
    ds_read_b128 v[132:135], v24 offset:3328
    s_waitcnt lgkmcnt(8)
    v_mfma_f32_16x16x32_bf16 v[48:51], v[88:91], v[96:99], v[48:51]
    ds_read_b64 v[64:65], v20 offset:3264
    ds_read_b64 v[66:67], v20 offset:3272
    v_mfma_f32_16x16x32_bf16 v[52:55], v[92:95], v[96:99], v[52:55]
    ds_read_b64 v[68:69], v20 offset:2240
    v_mfma_f32_16x16x32_bf16 v[52:55], v[88:91], v[100:103], v[52:55]
    ds_read_b64 v[70:71], v20 offset:2248
    v_mfma_f32_16x16x32_bf16 v[56:59], v[92:95], v[100:103], v[56:59]
    ds_read_b128 v[72:75], v25 offset:192
    v_mfma_f32_16x16x32_bf16 v[56:59], v[88:91], v[104:107], v[56:59]
    ds_read_b128 v[76:79], v25 offset:1216
    v_mfma_f32_16x16x32_bf16 v[60:63], v[92:95], v[104:107], v[60:63]
    ds_read_b128 v[80:83], v25 offset:2240
    v_mfma_f32_16x16x32_bf16 v[60:63], v[88:91], v[108:111], v[60:63]
    ds_read_b128 v[84:87], v25 offset:3264
    s_waitcnt lgkmcnt(8)
    v_mfma_f32_16x16x32_bf16 v[48:51], v[112:115], v[120:123], v[48:51]
    ds_read_b64 v[88:89], v20 offset:3200
    ds_read_b64 v[90:91], v20 offset:3208
    v_mfma_f32_16x16x32_bf16 v[52:55], v[116:119], v[120:123], v[52:55]
    ds_read_b64 v[92:93], v20 offset:2176
    v_mfma_f32_16x16x32_bf16 v[52:55], v[112:115], v[124:127], v[52:55]
    ds_read_b64 v[94:95], v20 offset:2184
    v_mfma_f32_16x16x32_bf16 v[56:59], v[116:119], v[124:127], v[56:59]
    ds_read_b128 v[96:99], v26 offset:128
    v_mfma_f32_16x16x32_bf16 v[56:59], v[112:115], v[128:131], v[56:59]
    ds_read_b128 v[100:103], v26 offset:1152
    v_mfma_f32_16x16x32_bf16 v[60:63], v[116:119], v[128:131], v[60:63]
    ds_read_b128 v[104:107], v26 offset:2176
    v_mfma_f32_16x16x32_bf16 v[60:63], v[112:115], v[132:135], v[60:63]
    ds_read_b128 v[108:111], v26 offset:3200
    s_waitcnt lgkmcnt(8)
    v_mfma_f32_16x16x32_bf16 v[48:51], v[64:67], v[72:75], v[48:51]
    ds_read_b64 v[112:113], v20 offset:3136
    ds_read_b64 v[114:115], v20 offset:3144
    v_mfma_f32_16x16x32_bf16 v[52:55], v[68:71], v[72:75], v[52:55]
    ds_read_b64 v[116:117], v20 offset:2112
    v_mfma_f32_16x16x32_bf16 v[52:55], v[64:67], v[76:79], v[52:55]
    ds_read_b64 v[118:119], v20 offset:2120
    v_mfma_f32_16x16x32_bf16 v[56:59], v[68:71], v[76:79], v[56:59]
    ds_read_b128 v[120:123], v27 offset:64
    v_mfma_f32_16x16x32_bf16 v[56:59], v[64:67], v[80:83], v[56:59]
    ds_read_b128 v[124:127], v27 offset:1088
    v_mfma_f32_16x16x32_bf16 v[60:63], v[68:71], v[80:83], v[60:63]
    ds_read_b128 v[128:131], v27 offset:2112
    v_mfma_f32_16x16x32_bf16 v[60:63], v[64:67], v[84:87], v[60:63]
    ds_read_b128 v[132:135], v27 offset:3136
    s_waitcnt lgkmcnt(8)
    v_mfma_f32_16x16x32_bf16 v[48:51], v[88:91], v[96:99], v[48:51]
    ds_read_b64 v[64:65], v20 offset:3072
    ds_read_b64 v[66:67], v20 offset:3080
    v_mfma_f32_16x16x32_bf16 v[52:55], v[92:95], v[96:99], v[52:55]
    ds_read_b64 v[68:69], v20 offset:2048
    v_mfma_f32_16x16x32_bf16 v[52:55], v[88:91], v[100:103], v[52:55]
    ds_read_b64 v[70:71], v20 offset:2056
    v_mfma_f32_16x16x32_bf16 v[56:59], v[92:95], v[100:103], v[56:59]
    ds_read_b128 v[72:75], v28 offset:0
    v_mfma_f32_16x16x32_bf16 v[56:59], v[88:91], v[104:107], v[56:59]
    ds_read_b128 v[76:79], v28 offset:1024
    v_mfma_f32_16x16x32_bf16 v[60:63], v[92:95], v[104:107], v[60:63]
    ds_read_b128 v[80:83], v28 offset:2048
    v_mfma_f32_16x16x32_bf16 v[60:63], v[88:91], v[108:111], v[60:63]
    ds_read_b128 v[84:87], v28 offset:3072
    s_waitcnt lgkmcnt(8)
    v_mfma_f32_16x16x32_bf16 v[48:51], v[112:115], v[120:123], v[48:51]
    ds_read_b64 v[88:89], v20 offset:1984
    v_mfma_f32_16x16x32_bf16 v[52:55], v[116:119], v[120:123], v[52:55]
    ds_read_b64 v[90:91], v20 offset:1992
    v_mfma_f32_16x16x32_bf16 v[52:55], v[112:115], v[124:127], v[52:55]
    ds_read_b64 v[92:93], v20 offset:960
    v_mfma_f32_16x16x32_bf16 v[56:59], v[116:119], v[124:127], v[56:59]
    ds_read_b64 v[94:95], v20 offset:968
    v_mfma_f32_16x16x32_bf16 v[56:59], v[112:115], v[128:131], v[56:59]
    ds_read_b128 v[96:99], v21 offset:960
    v_mfma_f32_16x16x32_bf16 v[60:63], v[116:119], v[128:131], v[60:63]
    ds_read_b128 v[100:103], v21 offset:1984
    v_mfma_f32_16x16x32_bf16 v[60:63], v[112:115], v[132:135], v[60:63]
    s_waitcnt lgkmcnt(6)
    v_mfma_f32_16x16x32_bf16 v[48:51], v[64:67], v[72:75], v[48:51]
    ds_read_b64 v[112:113], v20 offset:1920
    v_mfma_f32_16x16x32_bf16 v[52:55], v[64:67], v[76:79], v[52:55]
    ds_read_b64 v[114:115], v20 offset:1928
    v_mfma_f32_16x16x32_bf16 v[52:55], v[68:71], v[72:75], v[52:55]
    ds_read_b64 v[116:117], v20 offset:896
    v_mfma_f32_16x16x32_bf16 v[56:59], v[64:67], v[80:83], v[56:59]
    ds_read_b64 v[118:119], v20 offset:904
    v_mfma_f32_16x16x32_bf16 v[56:59], v[68:71], v[76:79], v[56:59]
    ds_read_b128 v[120:123], v22 offset:896
    v_mfma_f32_16x16x32_bf16 v[60:63], v[64:67], v[84:87], v[60:63]
    ds_read_b128 v[124:127], v22 offset:1920
    v_mfma_f32_16x16x32_bf16 v[60:63], v[68:71], v[80:83], v[60:63]
    s_waitcnt lgkmcnt(6)
    v_mfma_f32_16x16x32_bf16 v[60:63], v[88:91], v[100:103], v[60:63]
    ds_read_b64 v[64:65], v20 offset:1856
    ds_read_b64 v[66:67], v20 offset:1864
    v_mfma_f32_16x16x32_bf16 v[56:59], v[88:91], v[96:99], v[56:59]
    ds_read_b64 v[68:69], v20 offset:832
    ds_read_b64 v[70:71], v20 offset:840
    v_mfma_f32_16x16x32_bf16 v[60:63], v[92:95], v[96:99], v[60:63]
    ds_read_b128 v[72:75], v23 offset:832
    ds_read_b128 v[76:79], v23 offset:1856
    ds_write_b128 v34, v[48:51] offset:0
    ds_write_b128 v34, v[52:55] offset:1280
    ds_write_b32 v15, v16
    s_waitcnt lgkmcnt(9)
    v_mfma_f32_16x16x32_bf16 v[60:63], v[112:115], v[124:127], v[60:63]
    ds_read_b64 v[88:89], v20 offset:1792
    ds_read_b64 v[90:91], v20 offset:1800
    v_mfma_f32_16x16x32_bf16 v[56:59], v[112:115], v[120:123], v[56:59]
    ds_read_b64 v[92:93], v20 offset:768
    ds_read_b64 v[94:95], v20 offset:776
    v_mfma_f32_16x16x32_bf16 v[60:63], v[116:119], v[120:123], v[60:63]
    ds_read_b128 v[96:99], v24 offset:768
    ds_read_b128 v[100:103], v24 offset:1792
    s_waitcnt lgkmcnt(9)
    v_mfma_f32_16x16x32_bf16 v[60:63], v[64:67], v[76:79], v[60:63]
    ds_read_b64 v[112:113], v20 offset:1728
    ds_read_b64 v[114:115], v20 offset:1736
    v_mfma_f32_16x16x32_bf16 v[56:59], v[64:67], v[72:75], v[56:59]
    ds_read_b64 v[116:117], v20 offset:704
    ds_read_b64 v[118:119], v20 offset:712
    v_mfma_f32_16x16x32_bf16 v[60:63], v[68:71], v[72:75], v[60:63]
    ds_read_b128 v[120:123], v25 offset:704
    ds_read_b128 v[124:127], v25 offset:1728
    s_waitcnt lgkmcnt(6)
    v_mfma_f32_16x16x32_bf16 v[60:63], v[88:91], v[100:103], v[60:63]
    ds_read_b64 v[64:65], v20 offset:1664
    ds_read_b64 v[66:67], v20 offset:1672
    v_mfma_f32_16x16x32_bf16 v[56:59], v[88:91], v[96:99], v[56:59]
    ds_read_b64 v[68:69], v20 offset:640
    ds_read_b64 v[70:71], v20 offset:648
    v_mfma_f32_16x16x32_bf16 v[60:63], v[92:95], v[96:99], v[60:63]
    ds_read_b128 v[72:75], v26 offset:640
    ds_read_b128 v[76:79], v26 offset:1664
    s_waitcnt lgkmcnt(6)
    v_mfma_f32_16x16x32_bf16 v[60:63], v[112:115], v[124:127], v[60:63]
    ds_read_b64 v[88:89], v20 offset:1600
    ds_read_b64 v[90:91], v20 offset:1608
    v_mfma_f32_16x16x32_bf16 v[56:59], v[112:115], v[120:123], v[56:59]
    ds_read_b64 v[92:93], v20 offset:576
    ds_read_b64 v[94:95], v20 offset:584
    v_mfma_f32_16x16x32_bf16 v[60:63], v[116:119], v[120:123], v[60:63]
    ds_read_b128 v[96:99], v27 offset:576
    ds_read_b128 v[100:103], v27 offset:1600
    s_waitcnt lgkmcnt(6)
    v_mfma_f32_16x16x32_bf16 v[60:63], v[64:67], v[76:79], v[60:63]
    ds_read_b64 v[112:113], v20 offset:1536
    ds_read_b64 v[114:115], v20 offset:1544
    v_mfma_f32_16x16x32_bf16 v[56:59], v[64:67], v[72:75], v[56:59]
    ds_read_b64 v[116:117], v20 offset:512
    ds_read_b64 v[118:119], v20 offset:520
    v_mfma_f32_16x16x32_bf16 v[60:63], v[68:71], v[72:75], v[60:63]
    ds_read_b128 v[120:123], v28 offset:512
    ds_read_b128 v[124:127], v28 offset:1536
    s_waitcnt lgkmcnt(6)
    v_mfma_f32_16x16x32_bf16 v[60:63], v[88:91], v[100:103], v[60:63]
    ds_read_b64 v[64:65], v20 offset:1472
    ds_read_b64 v[66:67], v20 offset:1480
    v_mfma_f32_16x16x32_bf16 v[56:59], v[88:91], v[96:99], v[56:59]
    ds_read_b64 v[68:69], v20 offset:448
    ds_read_b64 v[70:71], v20 offset:456
    v_mfma_f32_16x16x32_bf16 v[60:63], v[92:95], v[96:99], v[60:63]
    ds_read_b128 v[72:75], v21 offset:448
    ds_read_b128 v[76:79], v21 offset:1472
    s_waitcnt lgkmcnt(6)
    v_mfma_f32_16x16x32_bf16 v[60:63], v[112:115], v[124:127], v[60:63]
    ds_read_b64 v[88:89], v20 offset:1408
    ds_read_b64 v[90:91], v20 offset:1416
    v_mfma_f32_16x16x32_bf16 v[56:59], v[112:115], v[120:123], v[56:59]
    ds_read_b64 v[92:93], v20 offset:384
    ds_read_b64 v[94:95], v20 offset:392
    v_mfma_f32_16x16x32_bf16 v[60:63], v[116:119], v[120:123], v[60:63]
    ds_read_b128 v[96:99], v22 offset:384
    ds_read_b128 v[100:103], v22 offset:1408
    s_waitcnt lgkmcnt(6)
    v_mfma_f32_16x16x32_bf16 v[60:63], v[64:67], v[76:79], v[60:63]
    ds_read_b64 v[112:113], v20 offset:1344
    ds_read_b64 v[114:115], v20 offset:1352
    v_mfma_f32_16x16x32_bf16 v[56:59], v[64:67], v[72:75], v[56:59]
    ds_read_b64 v[116:117], v20 offset:320
    ds_read_b64 v[118:119], v20 offset:328
    v_mfma_f32_16x16x32_bf16 v[60:63], v[68:71], v[72:75], v[60:63]
    ds_read_b128 v[120:123], v23 offset:320
    ds_read_b128 v[124:127], v23 offset:1344
    s_waitcnt lgkmcnt(6)
    v_mfma_f32_16x16x32_bf16 v[60:63], v[88:91], v[100:103], v[60:63]
    ds_read_b64 v[64:65], v20 offset:1280
    ds_read_b64 v[66:67], v20 offset:1288
    v_mfma_f32_16x16x32_bf16 v[56:59], v[88:91], v[96:99], v[56:59]
    ds_read_b64 v[68:69], v20 offset:256
    ds_read_b64 v[70:71], v20 offset:264
    v_mfma_f32_16x16x32_bf16 v[60:63], v[92:95], v[96:99], v[60:63]
    ds_read_b128 v[72:75], v24 offset:256
    ds_read_b128 v[76:79], v24 offset:1280
    s_waitcnt lgkmcnt(6)
    v_mfma_f32_16x16x32_bf16 v[60:63], v[112:115], v[124:127], v[60:63]
    ds_read_b64 v[88:89], v20 offset:1216
    ds_read_b64 v[90:91], v20 offset:1224
    v_mfma_f32_16x16x32_bf16 v[56:59], v[112:115], v[120:123], v[56:59]
    ds_read_b64 v[92:93], v20 offset:192
    ds_read_b64 v[94:95], v20 offset:200
    v_mfma_f32_16x16x32_bf16 v[60:63], v[116:119], v[120:123], v[60:63]
    ds_read_b128 v[96:99], v25 offset:192
    ds_read_b128 v[100:103], v25 offset:1216
    s_waitcnt lgkmcnt(6)
    v_mfma_f32_16x16x32_bf16 v[60:63], v[64:67], v[76:79], v[60:63]
    ds_read_b64 v[112:113], v20 offset:1152
    ds_read_b64 v[114:115], v20 offset:1160
    v_mfma_f32_16x16x32_bf16 v[56:59], v[64:67], v[72:75], v[56:59]
    ds_read_b64 v[116:117], v20 offset:128
    ds_read_b64 v[118:119], v20 offset:136
    v_mfma_f32_16x16x32_bf16 v[60:63], v[68:71], v[72:75], v[60:63]
    ds_read_b128 v[120:123], v26 offset:128
    ds_read_b128 v[124:127], v26 offset:1152
    s_waitcnt lgkmcnt(6)
    v_mfma_f32_16x16x32_bf16 v[60:63], v[88:91], v[100:103], v[60:63]
    ds_read_b64 v[64:65], v20 offset:1088
    ds_read_b64 v[66:67], v20 offset:1096
    v_mfma_f32_16x16x32_bf16 v[56:59], v[88:91], v[96:99], v[56:59]
    ds_read_b64 v[68:69], v20 offset:64
    ds_read_b64 v[70:71], v20 offset:72
    v_mfma_f32_16x16x32_bf16 v[60:63], v[92:95], v[96:99], v[60:63]
    ds_read_b128 v[72:75], v27 offset:64
    ds_read_b128 v[76:79], v27 offset:1088
    ds_write_b32 v15, v17
    s_waitcnt lgkmcnt(7)
    v_mfma_f32_16x16x32_bf16 v[60:63], v[112:115], v[124:127], v[60:63]
    ds_read_b64 v[88:89], v20 offset:1024
    ds_read_b64 v[90:91], v20 offset:1032
    v_mfma_f32_16x16x32_bf16 v[56:59], v[112:115], v[120:123], v[56:59]
    ds_read_b64 v[92:93], v20 offset:0
    ds_read_b64 v[94:95], v20 offset:8
    v_mfma_f32_16x16x32_bf16 v[60:63], v[116:119], v[120:123], v[60:63]
    ds_read_b128 v[96:99], v28 offset:0
    ds_read_b128 v[100:103], v28 offset:1024
    s_waitcnt lgkmcnt(7)
    v_mfma_f32_16x16x32_bf16 v[60:63], v[64:67], v[76:79], v[60:63]
    v_mfma_f32_16x16x32_bf16 v[56:59], v[64:67], v[72:75], v[56:59]
    v_mfma_f32_16x16x32_bf16 v[60:63], v[68:71], v[72:75], v[60:63]
    s_waitcnt lgkmcnt(0)
    v_mfma_f32_16x16x32_bf16 v[56:59], v[88:91], v[96:99], v[56:59]
    v_mfma_f32_16x16x32_bf16 v[60:63], v[88:91], v[100:103], v[60:63]
    v_mfma_f32_16x16x32_bf16 v[60:63], v[92:95], v[96:99], v[60:63]
    v_mov_b32 v16, 4
    s_nop 4
    ds_write_b128 v34, v[56:59] offset:2560
    s_nop 0
    ds_write_b128 v34, v[60:63] offset:3840
    ds_write_b32 v15, v16
    s_or_b32 s47, s2, s46
    s_cmp_lg_u32 s47, 0
    s_cbranch_scc1 C_end
    ds_read_b32 v4, v18 offset:28
    v_mov_b32 v5, 0
    s_waitcnt lgkmcnt(0)
    global_store_dword v5, v4, s[36:37]
C_end:
    s_endpgm
A_main:
    s_and_b32 s44, s42, 1
    s_mov_b32 s56, 0xffff0000
    s_add_u32 s46, s40, 3
    s_and_b32 s46, s46, 3
    s_mul_i32 s47, s46, 14416
    s_add_u32 s47, s47, 104832
    s_mov_b32 m0, s47
    s_mov_b32 s64, 0x3fb8aa3b
    s_mov_b32 s65, 0x3e22f983
    s_mov_b32 s66, 0x43b8aa3b
    s_mov_b32 s67, 0x4222f983
    v_mov_b32 v35, 0x3f80
    ds_write_addtid_b32 v35 offset:0
    v_mov_b64 v[12:13], 0
    v_mov_b64 v[14:15], 0
    s_mul_i32 s48, s46, 5120
    s_add_u32 s48, s48, 65536
    v_lshl_add_u32 v148, v0, 4, s48
    v_and_b32 v2, 7, v0
    v_lshlrev_b32 v2, 4, v2
    v_add_u32 v2, 86016, v2
    ds_write_b128 v2, v[12:15]
    s_mov_b32 s72, 0x9e37f1b5
    s_mov_b32 s73, 0x7b45c2d3
    s_mov_b32 s74, 0x5a8d3ee9
    s_mov_b32 s75, 0xc3a5b671
    s_mov_b64 s[68:69], s[36:37]
    s_mov_b32 s70, 3145728
    s_mov_b32 s71, 0x00020000
    v_and_b32 v1, 3, v0
    v_lshrrev_b32 v2, 2, v0
    s_lshl_b32 s47, s46, 4
    v_add_u32 v2, s47, v2
    v_mul_u32_u24 v136, 7, v1
    s_lshl_b32 s47, s43, 6
    s_add_u32 s47, s47, 1048576
    v_lshl_add_u32 v137, v2, 13, s47
    v_lshl_add_u32 v137, v1, 4, v137
    s_lshr_b32 s47, s43, 4
    s_lshl_b32 s47, s47, 2
    s_add_u32 s47, s47, s46
    s_lshl_b32 s47, s47, 12
    s_and_b32 s48, s43, 15
    s_lshl_b32 s48, s48, 2
    s_add_u32 s47, s47, s48
    s_add_u32 s47, s47, 65536
    v_lshl_add_u32 v138, v0, 6, s47
    s_lshl_b32 s47, s46, 10
    s_add_u32 s47, s47, 4096
    v_lshl_add_u32 v139, v0, 4, s47
    s_mov_b32 s12, 0x11111111
    s_mov_b32 s13, s12
    s_mov_b32 s9, 524288
    s_mov_b32 s5, 4096
    s_mov_b32 s14, 0x22222222
    s_mov_b32 s15, s14
    s_mov_b32 s10, 1048576
    s_mov_b32 s6, 8192
    s_mov_b32 s16, 0x44444444
    s_mov_b32 s17, s16
    s_mov_b32 s11, 1572864
    s_mov_b32 s7, 12288
    s_mov_b32 s18, 0x88888888
    s_mov_b32 s19, s18
    s_setprio 0
    s_lshl_b32 s47, s46, 2
    s_add_u32 s47, s47, 86016
    v_mov_b32 v146, s47
    v_mov_b32 v147, 1
    s_waitcnt lgkmcnt(0)
    s_barrier
    s_waitcnt vmcnt(0)
    v_mul_f32 v4, s64, v4
    v_exp_f32 v4, v4
    s_nop 0
    v_cvt_pk_bf16_f32 v4, v4, v4
    v_and_b32 v4, s56, v4
    v_pk_mul_f32 v[92:93], v[52:53], v[4:5] op_sel:[0,0] op_sel_hi:[1,0]
    v_pk_mul_f32 v[72:73], v[72:73], v[4:5] op_sel:[0,0] op_sel_hi:[1,0]
    v_pk_mul_f32 v[80:81], v[92:93], s[64:65]
    v_pk_mul_f32 v[70:71], v[72:73], v[94:95] op_sel:[0,0] op_sel_hi:[1,0]
    v_fract_f32 v81, v81
    v_exp_f32 v80, v80
    v_cos_f32 v52, v81
    v_sin_f32 v53, v81
    v_pk_fma_f32 v[70:71], v[72:73], v[94:95], v[70:71] op_sel:[1,1,0] op_sel_hi:[0,1,1] neg_lo:[1,0,0]
    v_pk_mul_f32 v[52:53], v[52:53], v[80:81] op_sel:[0,0] op_sel_hi:[1,0]
    v_cvt_pk_bf16_f32 v88, v70, -v71
    v_pk_mul_f32 v[58:59], v[52:53], v[52:53] op_sel:[0,0] op_sel_hi:[1,0]
    ds_write_addtid_b32 v88 offset:5712
    v_pk_fma_f32 v[58:59], v[52:53], v[52:53], v[58:59] op_sel:[1,1,0] op_sel_hi:[0,1,1] neg_lo:[1,0,0]
    v_pk_mul_f32 v[82:83], v[92:93], s[66:67]
    v_pk_mul_f32 v[62:63], v[58:59], v[58:59] op_sel:[0,0] op_sel_hi:[1,0]
    v_fract_f32 v83, v83
    v_pk_fma_f32 v[62:63], v[58:59], v[58:59], v[62:63] op_sel:[1,1,0] op_sel_hi:[0,1,1] neg_lo:[1,0,0]
    v_exp_f32 v82, v82
    v_pk_mul_f32 v[54:55], v[62:63], v[62:63] op_sel:[0,0] op_sel_hi:[1,0]
    v_cos_f32 v56, v83
    v_pk_fma_f32 v[54:55], v[62:63], v[62:63], v[54:55] op_sel:[1,1,0] op_sel_hi:[0,1,1] neg_lo:[1,0,0]
    v_sin_f32 v57, v83
    v_pk_mul_f32 v[72:73], v[70:71], v[54:55] op_sel:[0,0] op_sel_hi:[1,0]
    v_pk_mul_f32 v[56:57], v[56:57], v[82:83] op_sel:[0,0] op_sel_hi:[1,0]
    v_pk_fma_f32 v[72:73], v[70:71], v[54:55], v[72:73] op_sel:[1,1,0] op_sel_hi:[0,1,1] neg_lo:[1,0,0]
    v_pk_mul_f32 v[78:79], v[56:57], v[56:57] op_sel:[0,0] op_sel_hi:[1,0]
    v_pk_mul_f32 v[70:71], v[72:73], v[54:55] op_sel:[0,0] op_sel_hi:[1,0]
    v_cvt_pk_bf16_f32 v89, v72, -v73
    v_pk_fma_f32 v[70:71], v[72:73], v[54:55], v[70:71] op_sel:[1,1,0] op_sel_hi:[0,1,1] neg_lo:[1,0,0]
    ds_write_addtid_b32 v89 offset:5984
    v_pk_mul_f32 v[72:73], v[70:71], v[54:55] op_sel:[0,0] op_sel_hi:[1,0]
    v_cvt_pk_bf16_f32 v90, v70, -v71
    v_pk_fma_f32 v[72:73], v[70:71], v[54:55], v[72:73] op_sel:[1,1,0] op_sel_hi:[0,1,1] neg_lo:[1,0,0]
    ds_write_addtid_b32 v90 offset:6256
    v_pk_mul_f32 v[70:71], v[72:73], v[54:55] op_sel:[0,0] op_sel_hi:[1,0]
    v_cvt_pk_bf16_f32 v91, v72, -v73
    v_pk_fma_f32 v[70:71], v[72:73], v[54:55], v[70:71] op_sel:[1,1,0] op_sel_hi:[0,1,1] neg_lo:[1,0,0]
    ds_write_addtid_b32 v91 offset:6528
    v_pk_mul_f32 v[72:73], v[70:71], v[54:55] op_sel:[0,0] op_sel_hi:[1,0]
    v_cvt_pk_bf16_f32 v88, v70, -v71
    v_pk_fma_f32 v[72:73], v[70:71], v[54:55], v[72:73] op_sel:[1,1,0] op_sel_hi:[0,1,1] neg_lo:[1,0,0]
    ds_write_addtid_b32 v88 offset:6800
    v_pk_mul_f32 v[70:71], v[72:73], v[54:55] op_sel:[0,0] op_sel_hi:[1,0]
    v_cvt_pk_bf16_f32 v89, v72, -v73
    v_pk_fma_f32 v[70:71], v[72:73], v[54:55], v[70:71] op_sel:[1,1,0] op_sel_hi:[0,1,1] neg_lo:[1,0,0]
    ds_write_addtid_b32 v89 offset:7072
    v_pk_mul_f32 v[72:73], v[70:71], v[54:55] op_sel:[0,0] op_sel_hi:[1,0]
    v_cvt_pk_bf16_f32 v90, v70, -v71
    v_pk_fma_f32 v[72:73], v[70:71], v[54:55], v[72:73] op_sel:[1,1,0] op_sel_hi:[0,1,1] neg_lo:[1,0,0]
    ds_write_addtid_b32 v90 offset:7344
    v_pk_mul_f32 v[70:71], v[72:73], v[54:55] op_sel:[0,0] op_sel_hi:[1,0]
    v_cvt_pk_bf16_f32 v91, v72, -v73
    v_pk_fma_f32 v[70:71], v[72:73], v[54:55], v[70:71] op_sel:[1,1,0] op_sel_hi:[0,1,1] neg_lo:[1,0,0]
    ds_write_addtid_b32 v91 offset:7616
    v_pk_mul_f32 v[72:73], v[70:71], v[54:55] op_sel:[0,0] op_sel_hi:[1,0]
    v_cvt_pk_bf16_f32 v88, v70, -v71
    v_pk_fma_f32 v[72:73], v[70:71], v[54:55], v[72:73] op_sel:[1,1,0] op_sel_hi:[0,1,1] neg_lo:[1,0,0]
    ds_write_addtid_b32 v88 offset:7888
    v_pk_mul_f32 v[70:71], v[72:73], v[54:55] op_sel:[0,0] op_sel_hi:[1,0]
    v_cvt_pk_bf16_f32 v89, v72, -v73
    v_pk_fma_f32 v[70:71], v[72:73], v[54:55], v[70:71] op_sel:[1,1,0] op_sel_hi:[0,1,1] neg_lo:[1,0,0]
    ds_write_addtid_b32 v89 offset:8160
    v_pk_mul_f32 v[72:73], v[70:71], v[54:55] op_sel:[0,0] op_sel_hi:[1,0]
    v_cvt_pk_bf16_f32 v90, v70, -v71
    v_pk_fma_f32 v[72:73], v[70:71], v[54:55], v[72:73] op_sel:[1,1,0] op_sel_hi:[0,1,1] neg_lo:[1,0,0]
    ds_write_addtid_b32 v90 offset:8432
    v_pk_mul_f32 v[70:71], v[72:73], v[54:55] op_sel:[0,0] op_sel_hi:[1,0]
    v_cvt_pk_bf16_f32 v91, v72, -v73
    v_pk_fma_f32 v[70:71], v[72:73], v[54:55], v[70:71] op_sel:[1,1,0] op_sel_hi:[0,1,1] neg_lo:[1,0,0]
    ds_write_addtid_b32 v91 offset:8704
    v_pk_mul_f32 v[72:73], v[70:71], v[54:55] op_sel:[0,0] op_sel_hi:[1,0]
    v_cvt_pk_bf16_f32 v88, v70, -v71
    v_pk_fma_f32 v[72:73], v[70:71], v[54:55], v[72:73] op_sel:[1,1,0] op_sel_hi:[0,1,1] neg_lo:[1,0,0]
    ds_write_addtid_b32 v88 offset:8976
    v_pk_mul_f32 v[70:71], v[72:73], v[54:55] op_sel:[0,0] op_sel_hi:[1,0]
    v_cvt_pk_bf16_f32 v89, v72, -v73
    v_pk_fma_f32 v[70:71], v[72:73], v[54:55], v[70:71] op_sel:[1,1,0] op_sel_hi:[0,1,1] neg_lo:[1,0,0]
    ds_write_addtid_b32 v89 offset:9248
    v_pk_mul_f32 v[72:73], v[70:71], v[54:55] op_sel:[0,0] op_sel_hi:[1,0]
    v_cvt_pk_bf16_f32 v90, v70, -v71
    v_pk_fma_f32 v[72:73], v[70:71], v[54:55], v[72:73] op_sel:[1,1,0] op_sel_hi:[0,1,1] neg_lo:[1,0,0]
    ds_write_addtid_b32 v90 offset:9520
    v_pk_mul_f32 v[70:71], v[72:73], v[54:55] op_sel:[0,0] op_sel_hi:[1,0]
    v_cvt_pk_bf16_f32 v91, v72, -v73
    v_pk_fma_f32 v[70:71], v[72:73], v[54:55], v[70:71] op_sel:[1,1,0] op_sel_hi:[0,1,1] neg_lo:[1,0,0]
    ds_write_addtid_b32 v91 offset:9792
    v_pk_mul_f32 v[72:73], v[70:71], v[54:55] op_sel:[0,0] op_sel_hi:[1,0]
    v_cvt_pk_bf16_f32 v88, v70, -v71
    v_pk_fma_f32 v[72:73], v[70:71], v[54:55], v[72:73] op_sel:[1,1,0] op_sel_hi:[0,1,1] neg_lo:[1,0,0]
    ds_write_addtid_b32 v88 offset:10064
    v_pk_mul_f32 v[70:71], v[72:73], v[54:55] op_sel:[0,0] op_sel_hi:[1,0]
    v_cvt_pk_bf16_f32 v89, v72, -v73
    v_pk_fma_f32 v[70:71], v[72:73], v[54:55], v[70:71] op_sel:[1,1,0] op_sel_hi:[0,1,1] neg_lo:[1,0,0]
    ds_write_addtid_b32 v89 offset:10336
    v_pk_mul_f32 v[72:73], v[70:71], v[54:55] op_sel:[0,0] op_sel_hi:[1,0]
    v_cvt_pk_bf16_f32 v90, v70, -v71
    v_pk_fma_f32 v[72:73], v[70:71], v[54:55], v[72:73] op_sel:[1,1,0] op_sel_hi:[0,1,1] neg_lo:[1,0,0]
    ds_write_addtid_b32 v90 offset:10608
    v_pk_mul_f32 v[70:71], v[72:73], v[54:55] op_sel:[0,0] op_sel_hi:[1,0]
    v_cvt_pk_bf16_f32 v91, v72, -v73
    v_pk_fma_f32 v[70:71], v[72:73], v[54:55], v[70:71] op_sel:[1,1,0] op_sel_hi:[0,1,1] neg_lo:[1,0,0]
    ds_write_addtid_b32 v91 offset:10880
    v_pk_mul_f32 v[72:73], v[70:71], v[54:55] op_sel:[0,0] op_sel_hi:[1,0]
    v_cvt_pk_bf16_f32 v88, v70, -v71
    v_pk_fma_f32 v[72:73], v[70:71], v[54:55], v[72:73] op_sel:[1,1,0] op_sel_hi:[0,1,1] neg_lo:[1,0,0]
    v_pk_mul_f32 v[64:65], v[62:63], v[52:53] op_sel:[0,0] op_sel_hi:[1,0]
    v_pk_mul_f32 v[70:71], v[72:73], v[54:55] op_sel:[0,0] op_sel_hi:[1,0]
    v_cvt_pk_bf16_f32 v89, v72, -v73
    v_pk_fma_f32 v[70:71], v[72:73], v[54:55], v[70:71] op_sel:[1,1,0] op_sel_hi:[0,1,1] neg_lo:[1,0,0]
    v_pk_mul_f32 v[60:61], v[58:59], v[52:53] op_sel:[0,0] op_sel_hi:[1,0]
    v_pk_mul_f32 v[72:73], v[70:71], v[54:55] op_sel:[0,0] op_sel_hi:[1,0]
    v_cvt_pk_bf16_f32 v90, v70, -v71
    v_pk_fma_f32 v[72:73], v[70:71], v[54:55], v[72:73] op_sel:[1,1,0] op_sel_hi:[0,1,1] neg_lo:[1,0,0]
    v_pk_mul_f32 v[66:67], v[62:63], v[58:59] op_sel:[0,0] op_sel_hi:[1,0]
    v_pk_mul_f32 v[70:71], v[72:73], v[54:55] op_sel:[0,0] op_sel_hi:[1,0]
    v_cvt_pk_bf16_f32 v91, v72, -v73
    v_pk_fma_f32 v[70:71], v[72:73], v[54:55], v[70:71] op_sel:[1,1,0] op_sel_hi:[0,1,1] neg_lo:[1,0,0]
    v_pk_fma_f32 v[78:79], v[56:57], v[56:57], v[78:79] op_sel:[1,1,0] op_sel_hi:[0,1,1] neg_lo:[1,0,0]
    v_pk_mul_f32 v[72:73], v[70:71], v[54:55] op_sel:[0,0] op_sel_hi:[1,0]
    ds_write_addtid_b32 v88 offset:11152
    v_pk_fma_f32 v[72:73], v[70:71], v[54:55], v[72:73] op_sel:[1,1,0] op_sel_hi:[0,1,1] neg_lo:[1,0,0]
    v_cvt_pk_bf16_f32 v84, v52, v53
    v_pk_fma_f32 v[64:65], v[62:63], v[52:53], v[64:65] op_sel:[1,1,0] op_sel_hi:[0,1,1] neg_lo:[1,0,0]
    v_pk_mul_f32 v[80:81], v[56:57], v[58:59] op_sel:[0,0] op_sel_hi:[1,0]
    v_cvt_pk_bf16_f32 v88, v70, -v71
    ds_write_addtid_b32 v84 offset:272
    v_cvt_pk_bf16_f32 v85, v58, v59
    v_pk_fma_f32 v[60:61], v[58:59], v[52:53], v[60:61] op_sel:[1,1,0] op_sel_hi:[0,1,1] neg_lo:[1,0,0]
    v_pk_fma_f32 v[66:67], v[62:63], v[58:59], v[66:67] op_sel:[1,1,0] op_sel_hi:[0,1,1] neg_lo:[1,0,0]
    v_pk_mul_f32 v[82:83], v[56:57], v[62:63] op_sel:[0,0] op_sel_hi:[1,0]
    v_pk_mul_f32 v[74:75], v[78:79], v[56:57] op_sel:[0,0] op_sel_hi:[1,0]
    v_pk_mul_f32 v[70:71], v[72:73], v[54:55] op_sel:[0,0] op_sel_hi:[1,0]
    ds_write_addtid_b32 v85 offset:544
    v_cvt_pk_bf16_f32 v84, v64, v65
    v_pk_fma_f32 v[80:81], v[56:57], v[58:59], v[80:81] op_sel:[1,1,0] op_sel_hi:[0,1,1] neg_lo:[1,0,0]
    ds_write_addtid_b32 v84 offset:1360
    v_cvt_pk_bf16_f32 v85, v66, v67
    v_pk_mul_f32 v[68:69], v[62:63], v[60:61] op_sel:[0,0] op_sel_hi:[1,0]
    v_pk_fma_f32 v[82:83], v[56:57], v[62:63], v[82:83] op_sel:[1,1,0] op_sel_hi:[0,1,1] neg_lo:[1,0,0]
    v_pk_fma_f32 v[74:75], v[78:79], v[56:57], v[74:75] op_sel:[1,1,0] op_sel_hi:[0,1,1] neg_lo:[1,0,0]
    ds_write_addtid_b32 v89 offset:11424
    v_pk_fma_f32 v[70:71], v[72:73], v[54:55], v[70:71] op_sel:[1,1,0] op_sel_hi:[0,1,1] neg_lo:[1,0,0]
    v_cvt_pk_bf16_f32 v87, v60, v61
    ds_write_addtid_b32 v85 offset:1632
    v_cvt_pk_bf16_f32 v84, v80, v81
    v_cvt_pk_bf16_f32 v89, v72, -v73
    v_cvt_pk_bf16_f32 v86, v62, v63
    ds_write_addtid_b32 v87 offset:816
    v_pk_fma_f32 v[68:69], v[62:63], v[60:61], v[68:69] op_sel:[1,1,0] op_sel_hi:[0,1,1] neg_lo:[1,0,0]
    v_cvt_pk_bf16_f32 v85, v82, v83
    v_pk_mul_f32 v[80:81], v[56:57], v[66:67] op_sel:[0,0] op_sel_hi:[1,0]
    v_pk_mul_f32 v[76:77], v[74:75], v[56:57] op_sel:[0,0] op_sel_hi:[1,0]
    v_pk_mul_f32 v[72:73], v[70:71], v[54:55] op_sel:[0,0] op_sel_hi:[1,0]
    ds_write_addtid_b32 v86 offset:1088
    v_cvt_pk_bf16_f32 v87, v56, v57
    v_pk_mul_f32 v[82:83], v[78:79], v[62:63] op_sel:[0,0] op_sel_hi:[1,0]
    v_cvt_pk_bf16_f32 v86, v68, v69
    ds_write_addtid_b32 v87 offset:2176
    v_pk_fma_f32 v[80:81], v[56:57], v[66:67], v[80:81] op_sel:[1,1,0] op_sel_hi:[0,1,1] neg_lo:[1,0,0]
    ds_write_addtid_b32 v90 offset:11696
    v_pk_fma_f32 v[76:77], v[74:75], v[56:57], v[76:77] op_sel:[1,1,0] op_sel_hi:[0,1,1] neg_lo:[1,0,0]
    v_pk_fma_f32 v[72:73], v[70:71], v[54:55], v[72:73] op_sel:[1,1,0] op_sel_hi:[0,1,1] neg_lo:[1,0,0]
    ds_write_addtid_b32 v86 offset:1904
    v_cvt_pk_bf16_f32 v87, v78, v79
    v_pk_fma_f32 v[82:83], v[78:79], v[62:63], v[82:83] op_sel:[1,1,0] op_sel_hi:[0,1,1] neg_lo:[1,0,0]
    v_cvt_pk_bf16_f32 v90, v70, -v71
    v_cvt_pk_bf16_f32 v86, v80, v81
    v_pk_mul_f32 v[78:79], v[76:77], v[56:57] op_sel:[0,0] op_sel_hi:[1,0]
    v_pk_mul_f32 v[70:71], v[72:73], v[54:55] op_sel:[0,0] op_sel_hi:[1,0]
    v_pk_mul_f32 v[80:81], v[74:75], v[62:63] op_sel:[0,0] op_sel_hi:[1,0]
    ds_write_addtid_b32 v85 offset:2720
    ds_write_addtid_b32 v91 offset:11968
    v_pk_fma_f32 v[78:79], v[76:77], v[56:57], v[78:79] op_sel:[1,1,0] op_sel_hi:[0,1,1] neg_lo:[1,0,0]
    v_pk_fma_f32 v[70:71], v[72:73], v[54:55], v[70:71] op_sel:[1,1,0] op_sel_hi:[0,1,1] neg_lo:[1,0,0]
    v_cvt_pk_bf16_f32 v85, v74, v75
    v_pk_fma_f32 v[80:81], v[74:75], v[62:63], v[80:81] op_sel:[1,1,0] op_sel_hi:[0,1,1] neg_lo:[1,0,0]
    v_cvt_pk_bf16_f32 v91, v72, -v73
    v_pk_mul_f32 v[74:75], v[78:79], v[56:57] op_sel:[0,0] op_sel_hi:[1,0]
    v_pk_mul_f32 v[72:73], v[70:71], v[54:55] op_sel:[0,0] op_sel_hi:[1,0]
    ds_write_addtid_b32 v87 offset:3264
    ds_write_addtid_b32 v88 offset:12240
    v_pk_fma_f32 v[74:75], v[78:79], v[56:57], v[74:75] op_sel:[1,1,0] op_sel_hi:[0,1,1] neg_lo:[1,0,0]
    v_pk_fma_f32 v[72:73], v[70:71], v[54:55], v[72:73] op_sel:[1,1,0] op_sel_hi:[0,1,1] neg_lo:[1,0,0]
    v_cvt_pk_bf16_f32 v87, v76, v77
    v_cvt_pk_bf16_f32 v88, v70, -v71
    ds_write_addtid_b32 v84 offset:2448
    v_pk_mul_f32 v[76:77], v[74:75], v[56:57] op_sel:[0,0] op_sel_hi:[1,0]
    v_pk_mul_f32 v[70:71], v[72:73], v[54:55] op_sel:[0,0] op_sel_hi:[1,0]
    v_cvt_pk_bf16_f32 v84, v82, v83
    ds_write_addtid_b32 v84 offset:3536
    ds_write_addtid_b32 v89 offset:12512
    v_pk_fma_f32 v[76:77], v[74:75], v[56:57], v[76:77] op_sel:[1,1,0] op_sel_hi:[0,1,1] neg_lo:[1,0,0]
    v_pk_fma_f32 v[70:71], v[72:73], v[54:55], v[70:71] op_sel:[1,1,0] op_sel_hi:[0,1,1] neg_lo:[1,0,0]
    v_cvt_pk_bf16_f32 v84, v78, v79
    v_cvt_pk_bf16_f32 v89, v72, -v73
    v_pk_mul_f32 v[78:79], v[76:77], v[56:57] op_sel:[0,0] op_sel_hi:[1,0]
    v_pk_mul_f32 v[72:73], v[70:71], v[54:55] op_sel:[0,0] op_sel_hi:[1,0]
    ds_write_addtid_b32 v86 offset:2992
    v_cvt_pk_bf16_f32 v86, v80, v81
    v_pk_fma_f32 v[78:79], v[76:77], v[56:57], v[78:79] op_sel:[1,1,0] op_sel_hi:[0,1,1] neg_lo:[1,0,0]
    v_pk_fma_f32 v[72:73], v[70:71], v[54:55], v[72:73] op_sel:[1,1,0] op_sel_hi:[0,1,1] neg_lo:[1,0,0]
    ds_write_addtid_b32 v85 offset:3808
    ds_write_addtid_b32 v86 offset:4080
    ds_write_addtid_b32 v87 offset:4352
    ds_write_addtid_b32 v90 offset:12784
    ds_write_addtid_b32 v91 offset:13056
    v_cvt_pk_bf16_f32 v85, v74, v75
    v_cvt_pk_bf16_f32 v86, v76, v77
    v_cvt_pk_bf16_f32 v90, v70, -v71
    v_cvt_pk_bf16_f32 v87, v78, v79
    v_cvt_pk_bf16_f32 v91, v72, -v73
    ds_write_addtid_b32 v84 offset:4624
    ds_write_addtid_b32 v85 offset:4896
    ds_write_addtid_b32 v88 offset:13328
    ds_write_addtid_b32 v86 offset:5168
    ds_write_addtid_b32 v89 offset:13600
    ds_write_addtid_b32 v90 offset:13872
    ds_write_addtid_b32 v87 offset:5440
    ds_write_addtid_b32 v91 offset:14144
    v_mov_b32 v104, 86016
    s_mov_b32 s57, 100000
    s_waitcnt lgkmcnt(0)
    s_barrier
    s_setprio 2
    buffer_load_dwordx4 v[4:7], v137, s[68:71], 0 offen sc1
    buffer_load_dwordx4 v[20:23], v139, s[68:71], 0 offen sc1
    ds_read_b32 v3, v104 offset:28
    v_mov_b64 v[108:109], 0
    v_mov_b64 v[110:111], 0
    ds_write_b128 v148, v[108:111]
    s_mov_b64 s[64:65], s[32:33]
    s_mov_b32 s66, 2097152
    s_mov_b32 s67, 0x00020000
    s_lshl_b32 s47, s43, 3
    s_lshl_b32 s48, s44, 10
    buffer_load_dwordx4 v[8:11], v137, s[68:71], s9 offen sc1
    buffer_load_dwordx4 v[24:27], v139, s[68:71], s5 offen sc1
    s_add_u32 s47, s47, s48
    v_lshl_add_u32 v142, v2, 13, s47
    v_lshl_add_u32 v142, v1, 11, v142
    s_and_b32 s47, s46, 1
    s_lshl_b32 s47, s47, 5
    s_lshl_b32 s48, s46, 8
    s_add_u32 s48, s48, 66560
    v_lshlrev_b32 v2, 2, v0
    v_xor_b32 v2, s47, v2
    buffer_load_dwordx4 v[12:15], v137, s[68:71], s10 offen sc1
    buffer_load_dwordx4 v[28:31], v139, s[68:71], s6 offen sc1
    v_add_u32 v140, s48, v2
    s_lshl_b32 s47, s46, 6
    s_add_u32 s47, s47, 9024
    s_movk_i32 s48, 288
    v_lshl_add_u32 v2, v1, 2, s47
    v_and_b32 v1, 48, v0
    v_add_u32 v2, v1, v2
    v_bfe_u32 v1, v0, 2, 2
    v_mad_u32_u24 v141, v1, s48, v2
    buffer_load_dwordx4 v[16:19], v137, s[68:71], s11 offen sc1
    buffer_load_dwordx4 v[32:35], v139, s[68:71], s7 offen sc1
    s_nop 0
    buffer_load_dword v36, v138, s[68:71], 0 offen sc1
    v_mov_b32 v1, 86016
    s_waitcnt lgkmcnt(0)
    v_readfirstlane_b32 s39, v3
    s_waitcnt vmcnt(7)
    s_nop 0
    v_add_u32 v113, s39, v23
    v_dot2_u32_u16 v37, v4, s72, v113
    v_lshlrev_b32 v114, 16, v22
    v_dot2_u32_u16 v37, v5, s73, v37
    v_and_b32 v115, s56, v22
    v_dot2_u32_u16 v37, v6, s74, v37
    v_pk_mul_f32 v[114:115], v[114:115], v[20:21] neg_lo:[1,0] neg_hi:[1,0]
    v_dot2_u32_u16 v37, v7, s75, v37
    v_lshlrev_b32 v40, 16, v4
    v_and_b32 v41, s56, v4
    v_lshlrev_b32 v44, 16, v6
    v_alignbit_b32 v37, v37, v37, v136
    v_and_b32 v45, s56, v6
    v_pk_fma_f32 v[72:73], v[40:41], v[20:21], v[114:115] op_sel:[0,0,0] op_sel_hi:[1,0,0]
    v_lshlrev_b32 v42, 16, v5
    v_and_b32 v43, s56, v5
    v_pk_fma_f32 v[76:77], v[44:45], v[20:21], v[114:115] op_sel:[0,1,1] op_sel_hi:[1,1,1]
    v_lshlrev_b32 v46, 16, v7
    v_and_b32 v47, s56, v7
    v_pk_fma_f32 v[74:75], v[42:43], v[20:21], v[114:115] op_sel:[0,0,0] op_sel_hi:[1,0,0]
    v_pk_fma_f32 v[78:79], v[46:47], v[20:21], v[114:115] op_sel:[0,1,1] op_sel_hi:[1,1,1]
    v_add_u32_dpp v37, v37, v37 quad_perm:[1,0,3,2] row_mask:0xf bank_mask:0xf
    v_cvt_pk_bf16_f32 v104, v72, v76
    v_cvt_pk_bf16_f32 v105, v73, v77
    v_cvt_pk_bf16_f32 v106, v74, v78
    v_cvt_pk_bf16_f32 v107, v75, v79
    ds_write2st64_b32 v140, v104, v105 offset0:0 offset1:20
    ds_write2st64_b32 v140, v106, v107 offset0:40 offset1:60
    v_add_u32_dpp v37, v37, v37 quad_perm:[2,3,0,1] row_mask:0xf bank_mask:0xf
    s_waitcnt vmcnt(5)
    v_add_u32 v113, s39, v27
    v_dot2_u32_u16 v112, v8, s72, v113
    v_lshlrev_b32 v114, 16, v26
    v_dot2_u32_u16 v112, v9, s73, v112
    v_and_b32 v115, s56, v26
    v_dot2_u32_u16 v112, v10, s74, v112
    v_pk_mul_f32 v[114:115], v[114:115], v[24:25] neg_lo:[1,0] neg_hi:[1,0]
    v_dot2_u32_u16 v112, v11, s75, v112
    v_lshlrev_b32 v48, 16, v8
    v_and_b32 v49, s56, v8
    v_lshlrev_b32 v52, 16, v10
    v_alignbit_b32 v112, v112, v112, v136
    v_and_b32 v53, s56, v10
    v_pk_fma_f32 v[80:81], v[48:49], v[24:25], v[114:115] op_sel:[0,0,0] op_sel_hi:[1,0,0]
    v_lshlrev_b32 v50, 16, v9
    v_and_b32 v51, s56, v9
    v_pk_fma_f32 v[84:85], v[52:53], v[24:25], v[114:115] op_sel:[0,1,1] op_sel_hi:[1,1,1]
    v_lshlrev_b32 v54, 16, v11
    v_and_b32 v55, s56, v11
    v_add_u32_dpp v112, v112, v112 quad_perm:[1,0,3,2] row_mask:0xf bank_mask:0xf
    v_pk_fma_f32 v[82:83], v[50:51], v[24:25], v[114:115] op_sel:[0,0,0] op_sel_hi:[1,0,0]
    v_pk_fma_f32 v[86:87], v[54:55], v[24:25], v[114:115] op_sel:[0,1,1] op_sel_hi:[1,1,1]
    v_cvt_pk_bf16_f32 v104, v80, v84
    v_cvt_pk_bf16_f32 v105, v81, v85
    v_cvt_pk_bf16_f32 v106, v82, v86
    v_cvt_pk_bf16_f32 v107, v83, v87
    ds_write2st64_b32 v140, v104, v105 offset0:4 offset1:24
    v_add_u32_dpp v112, v112, v112 quad_perm:[2,3,0,1] row_mask:0xf bank_mask:0xf
    ds_write2st64_b32 v140, v106, v107 offset0:44 offset1:64
    v_cndmask_b32 v37, v37, v112, s[14:15]
    s_waitcnt vmcnt(3)
    v_add_u32 v113, s39, v31
    v_dot2_u32_u16 v112, v12, s72, v113
    v_lshlrev_b32 v114, 16, v30
    v_dot2_u32_u16 v112, v13, s73, v112
    v_and_b32 v115, s56, v30
    v_dot2_u32_u16 v112, v14, s74, v112
    v_pk_mul_f32 v[114:115], v[114:115], v[28:29] neg_lo:[1,0] neg_hi:[1,0]
    v_dot2_u32_u16 v112, v15, s75, v112
    v_lshlrev_b32 v56, 16, v12
    v_and_b32 v57, s56, v12
    v_lshlrev_b32 v60, 16, v14
    v_alignbit_b32 v112, v112, v112, v136
    v_and_b32 v61, s56, v14
    v_pk_fma_f32 v[88:89], v[56:57], v[28:29], v[114:115] op_sel:[0,0,0] op_sel_hi:[1,0,0]
    v_lshlrev_b32 v58, 16, v13
    v_and_b32 v59, s56, v13
    v_pk_fma_f32 v[92:93], v[60:61], v[28:29], v[114:115] op_sel:[0,1,1] op_sel_hi:[1,1,1]
    v_lshlrev_b32 v62, 16, v15
    v_and_b32 v63, s56, v15
    v_add_u32_dpp v112, v112, v112 quad_perm:[1,0,3,2] row_mask:0xf bank_mask:0xf
    v_pk_fma_f32 v[90:91], v[58:59], v[28:29], v[114:115] op_sel:[0,0,0] op_sel_hi:[1,0,0]
    v_pk_fma_f32 v[94:95], v[62:63], v[28:29], v[114:115] op_sel:[0,1,1] op_sel_hi:[1,1,1]
    v_cvt_pk_bf16_f32 v104, v88, v92
    v_cvt_pk_bf16_f32 v105, v89, v93
    v_cvt_pk_bf16_f32 v106, v90, v94
    v_cvt_pk_bf16_f32 v107, v91, v95
    ds_write2st64_b32 v140, v104, v105 offset0:8 offset1:28
    v_add_u32_dpp v112, v112, v112 quad_perm:[2,3,0,1] row_mask:0xf bank_mask:0xf
    ds_write2st64_b32 v140, v106, v107 offset0:48 offset1:68
    v_cndmask_b32 v37, v37, v112, s[16:17]
    s_waitcnt vmcnt(1)
    v_add_u32 v113, s39, v35
    v_dot2_u32_u16 v112, v16, s72, v113
    v_lshlrev_b32 v114, 16, v34
    v_dot2_u32_u16 v112, v17, s73, v112
    v_and_b32 v115, s56, v34
    v_dot2_u32_u16 v112, v18, s74, v112
    v_pk_mul_f32 v[114:115], v[114:115], v[32:33] neg_lo:[1,0] neg_hi:[1,0]
    v_dot2_u32_u16 v112, v19, s75, v112
    v_lshlrev_b32 v64, 16, v16
    v_and_b32 v65, s56, v16
    v_lshlrev_b32 v68, 16, v18
    v_alignbit_b32 v112, v112, v112, v136
    v_and_b32 v69, s56, v18
    v_pk_fma_f32 v[96:97], v[64:65], v[32:33], v[114:115] op_sel:[0,0,0] op_sel_hi:[1,0,0]
    v_lshlrev_b32 v66, 16, v17
    v_and_b32 v67, s56, v17
    v_pk_fma_f32 v[100:101], v[68:69], v[32:33], v[114:115] op_sel:[0,1,1] op_sel_hi:[1,1,1]
    v_lshlrev_b32 v70, 16, v19
    v_and_b32 v71, s56, v19
    v_add_u32_dpp v112, v112, v112 quad_perm:[1,0,3,2] row_mask:0xf bank_mask:0xf
    v_pk_fma_f32 v[98:99], v[66:67], v[32:33], v[114:115] op_sel:[0,0,0] op_sel_hi:[1,0,0]
    v_pk_fma_f32 v[102:103], v[70:71], v[32:33], v[114:115] op_sel:[0,1,1] op_sel_hi:[1,1,1]
    v_cvt_pk_bf16_f32 v104, v96, v100
    v_cvt_pk_bf16_f32 v105, v97, v101
    v_cvt_pk_bf16_f32 v106, v98, v102
    v_cvt_pk_bf16_f32 v107, v99, v103
    ds_write2st64_b32 v140, v104, v105 offset0:12 offset1:32
    v_add_u32_dpp v112, v112, v112 quad_perm:[2,3,0,1] row_mask:0xf bank_mask:0xf
    ds_write2st64_b32 v140, v106, v107 offset0:52 offset1:72
    v_cndmask_b32 v37, v37, v112, s[18:19]
    s_waitcnt vmcnt(0)
    v_cmp_ne_u32 s[58:59], v37, v36
    s_nop 0
    s_cmp_lg_u64 s[58:59], 0
    s_cbranch_scc1 A_retry
A_ready:
    ds_write_b32 v146, v147 offset:48
    s_setprio 0
    s_cmp_eq_u32 s44, 1
    s_cbranch_scc1 A_pre1
    v_mul_f32 v104, 0xbfb8aa3b, v72
    v_mul_f32 v105, 0xbfb8aa3b, v73
    v_mul_f32 v106, 0xbfb8aa3b, v74
    v_mul_f32 v107, 0xbfb8aa3b, v75
    v_mul_f32 v108, 0xbfb8aa3b, v80
    v_mul_f32 v109, 0xbfb8aa3b, v81
    v_mul_f32 v110, 0xbfb8aa3b, v82
    v_mul_f32 v111, 0xbfb8aa3b, v83
    v_exp_f32 v104, v104
    v_exp_f32 v105, v105
    v_exp_f32 v106, v106
    v_exp_f32 v107, v107
    v_exp_f32 v108, v108
    v_exp_f32 v109, v109
    v_exp_f32 v110, v110
    v_exp_f32 v111, v111
    v_add_f32 v104, 1.0, v104
    v_add_f32 v105, 1.0, v105
    v_add_f32 v106, 1.0, v106
    v_add_f32 v107, 1.0, v107
    v_add_f32 v108, 1.0, v108
    v_add_f32 v109, 1.0, v109
    v_add_f32 v110, 1.0, v110
    v_add_f32 v111, 1.0, v111
    v_rcp_f32 v104, v104
    v_rcp_f32 v105, v105
    v_rcp_f32 v106, v106
    v_rcp_f32 v107, v107
    v_rcp_f32 v108, v108
    v_rcp_f32 v109, v109
    v_rcp_f32 v110, v110
    v_rcp_f32 v111, v111
    v_mul_f32 v4, v72, v104
    v_mul_f32 v5, v73, v105
    v_mul_f32 v6, v74, v106
    v_mul_f32 v7, v75, v107
    v_mul_f32 v8, v80, v108
    v_mul_f32 v9, v81, v109
    v_mul_f32 v10, v82, v110
    v_mul_f32 v11, v83, v111
    v_mul_f32 v104, 0xbfb8aa3b, v88
    v_mul_f32 v105, 0xbfb8aa3b, v89
    v_mul_f32 v106, 0xbfb8aa3b, v90
    v_mul_f32 v107, 0xbfb8aa3b, v91
    v_mul_f32 v108, 0xbfb8aa3b, v96
    v_mul_f32 v109, 0xbfb8aa3b, v97
    v_mul_f32 v110, 0xbfb8aa3b, v98
    v_mul_f32 v111, 0xbfb8aa3b, v99
    v_exp_f32 v104, v104
    v_exp_f32 v105, v105
    v_exp_f32 v106, v106
    v_exp_f32 v107, v107
    v_exp_f32 v108, v108
    v_exp_f32 v109, v109
    v_exp_f32 v110, v110
    v_exp_f32 v111, v111
    v_add_f32 v104, 1.0, v104
    v_add_f32 v105, 1.0, v105
    v_add_f32 v106, 1.0, v106
    v_add_f32 v107, 1.0, v107
    v_add_f32 v108, 1.0, v108
    v_add_f32 v109, 1.0, v109
    v_add_f32 v110, 1.0, v110
    v_add_f32 v111, 1.0, v111
    v_rcp_f32 v104, v104
    v_rcp_f32 v105, v105
    v_rcp_f32 v106, v106
    v_rcp_f32 v107, v107
    v_rcp_f32 v108, v108
    v_rcp_f32 v109, v109
    v_rcp_f32 v110, v110
    v_rcp_f32 v111, v111
    v_mul_f32 v12, v88, v104
    v_mul_f32 v13, v89, v105
    v_mul_f32 v14, v90, v106
    v_mul_f32 v15, v91, v107
    v_mul_f32 v16, v96, v108
    v_mul_f32 v17, v97, v109
    v_mul_f32 v18, v98, v110
    v_mul_f32 v19, v99, v111
    s_branch A_pre2
A_pre1:
    v_mul_f32 v104, 0xbfb8aa3b, v76
    v_mul_f32 v105, 0xbfb8aa3b, v77
    v_mul_f32 v106, 0xbfb8aa3b, v78
    v_mul_f32 v107, 0xbfb8aa3b, v79
    v_mul_f32 v108, 0xbfb8aa3b, v84
    v_mul_f32 v109, 0xbfb8aa3b, v85
    v_mul_f32 v110, 0xbfb8aa3b, v86
    v_mul_f32 v111, 0xbfb8aa3b, v87
    v_exp_f32 v104, v104
    v_exp_f32 v105, v105
    v_exp_f32 v106, v106
    v_exp_f32 v107, v107
    v_exp_f32 v108, v108
    v_exp_f32 v109, v109
    v_exp_f32 v110, v110
    v_exp_f32 v111, v111
    v_add_f32 v104, 1.0, v104
    v_add_f32 v105, 1.0, v105
    v_add_f32 v106, 1.0, v106
    v_add_f32 v107, 1.0, v107
    v_add_f32 v108, 1.0, v108
    v_add_f32 v109, 1.0, v109
    v_add_f32 v110, 1.0, v110
    v_add_f32 v111, 1.0, v111
    v_rcp_f32 v104, v104
    v_rcp_f32 v105, v105
    v_rcp_f32 v106, v106
    v_rcp_f32 v107, v107
    v_rcp_f32 v108, v108
    v_rcp_f32 v109, v109
    v_rcp_f32 v110, v110
    v_rcp_f32 v111, v111
    v_mul_f32 v4, v76, v104
    v_mul_f32 v5, v77, v105
    v_mul_f32 v6, v78, v106
    v_mul_f32 v7, v79, v107
    v_mul_f32 v8, v84, v108
    v_mul_f32 v9, v85, v109
    v_mul_f32 v10, v86, v110
    v_mul_f32 v11, v87, v111
    v_mul_f32 v104, 0xbfb8aa3b, v92
    v_mul_f32 v105, 0xbfb8aa3b, v93
    v_mul_f32 v106, 0xbfb8aa3b, v94
    v_mul_f32 v107, 0xbfb8aa3b, v95
    v_mul_f32 v108, 0xbfb8aa3b, v100
    v_mul_f32 v109, 0xbfb8aa3b, v101
    v_mul_f32 v110, 0xbfb8aa3b, v102
    v_mul_f32 v111, 0xbfb8aa3b, v103
    v_exp_f32 v104, v104
    v_exp_f32 v105, v105
    v_exp_f32 v106, v106
    v_exp_f32 v107, v107
    v_exp_f32 v108, v108
    v_exp_f32 v109, v109
    v_exp_f32 v110, v110
    v_exp_f32 v111, v111
    v_add_f32 v104, 1.0, v104
    v_add_f32 v105, 1.0, v105
    v_add_f32 v106, 1.0, v106
    v_add_f32 v107, 1.0, v107
    v_add_f32 v108, 1.0, v108
    v_add_f32 v109, 1.0, v109
    v_add_f32 v110, 1.0, v110
    v_add_f32 v111, 1.0, v111
    v_rcp_f32 v104, v104
    v_rcp_f32 v105, v105
    v_rcp_f32 v106, v106
    v_rcp_f32 v107, v107
    v_rcp_f32 v108, v108
    v_rcp_f32 v109, v109
    v_rcp_f32 v110, v110
    v_rcp_f32 v111, v111
    v_mov_b32 v40, v44
    v_mov_b32 v41, v45
    v_mov_b32 v42, v46
    v_mov_b32 v43, v47
    v_mov_b32 v48, v52
    v_mov_b32 v49, v53
    v_mov_b32 v50, v54
    v_mov_b32 v51, v55
    v_mul_f32 v12, v92, v104
    v_mov_b32 v56, v60
    v_mul_f32 v13, v93, v105
    v_mov_b32 v57, v61
    v_mul_f32 v14, v94, v106
    v_mov_b32 v58, v62
    v_mul_f32 v15, v95, v107
    v_mov_b32 v59, v63
    v_mul_f32 v16, v100, v108
    v_mov_b32 v64, v68
    v_mul_f32 v17, v101, v109
    v_mov_b32 v65, v69
    v_mul_f32 v18, v102, v110
    v_mov_b32 v66, v70
    v_mul_f32 v19, v103, v111
    v_mov_b32 v67, v71
A_pre2:
    s_setprio 3
    s_mov_b32 s57, 4000000
A_sel_w:
    ds_read_b32 v2, v1 offset:16
    s_waitcnt lgkmcnt(0)
    v_readfirstlane_b32 s47, v2
    s_nop 0
    s_cmp_lg_u32 s47, 0
    s_cbranch_scc1 A_sel_g
    s_sleep 1
    s_sub_u32 s57, s57, 1
    s_cmp_lg_u32 s57, 0
    s_cbranch_scc1 A_sel_w
A_sel_g:
    s_sub_u32 s47, s47, 1
    s_lshl_b32 s47, s47, 10
    s_lshl_b32 s48, s43, 3
    s_add_u32 s47, s47, s48
    v_mov_b32 v3, 0x7ffffff0
    s_sub_u32 s48, s47, 1572864
    v_cmp_ne_u32 vcc, s48, v142
    s_nop 1
    v_cndmask_b32 v145, v3, v142, vcc
    s_sub_u32 s48, s47, 1048576
    v_cmp_ne_u32 vcc, s48, v142
    s_nop 1
    v_cndmask_b32 v144, v3, v142, vcc
    s_sub_u32 s48, s47, 524288
    v_cmp_ne_u32 vcc, s48, v142
    s_nop 1
    v_cndmask_b32 v143, v3, v142, vcc
    s_sub_u32 s48, s47, 0
    v_cmp_ne_u32 vcc, s48, v142
    s_nop 1
    v_cndmask_b32 v142, v3, v142, vcc
    s_mov_b32 s57, 4000000
A_y0_w:
    ds_read_b128 v[104:107], v1 offset:0
    s_waitcnt lgkmcnt(0)
    v_min3_u32 v104, v104, v105, v106
    v_min_u32 v104, v104, v107
    s_nop 0
    v_readfirstlane_b32 s47, v104
    s_nop 0
    s_cmp_lg_u32 s47, 0
    s_cbranch_scc1 A_y0_g
    s_sleep 3
    s_sub_u32 s57, s57, 1
    s_cmp_lg_u32 s57, 0
    s_cbranch_scc1 A_y0_w
A_y0_g:
    ds_read2st64_b32 v[116:117], v141 offset0:0 offset1:64
    ds_read2st64_b32 v[118:119], v141 offset0:128 offset1:192
    ds_read2st64_b32 v[120:121], v141 offset0:5 offset1:69
    ds_read2st64_b32 v[122:123], v141 offset0:133 offset1:197
    s_waitcnt lgkmcnt(2)
    v_fma_f32 v116, v116, v4, v40
    v_fma_f32 v117, v117, v5, v41
    v_fma_f32 v118, v118, v6, v42
    v_fma_f32 v119, v119, v7, v43
    v_cvt_pk_bf16_f32 v116, v116, v117
    v_cvt_pk_bf16_f32 v117, v118, v119
    buffer_store_dwordx2 v[116:117], v142, s[64:67], 0 offen
    s_waitcnt lgkmcnt(0)
    v_fma_f32 v120, v120, v8, v48
    v_fma_f32 v121, v121, v9, v49
    v_fma_f32 v122, v122, v10, v50
    v_fma_f32 v123, v123, v11, v51
    v_cvt_pk_bf16_f32 v120, v120, v121
    v_cvt_pk_bf16_f32 v121, v122, v123
    buffer_store_dwordx2 v[120:121], v143, s[64:67], s9 offen
    s_mov_b32 s57, 4000000
A_y2_w:
    ds_read_b128 v[104:107], v1 offset:0
    s_waitcnt lgkmcnt(0)
    v_min3_u32 v104, v104, v105, v106
    v_min_u32 v104, v104, v107
    s_nop 0
    v_readfirstlane_b32 s47, v104
    s_nop 0
    s_lshr_b32 s47, s47, 2
    s_cmp_lg_u32 s47, 0
    s_cbranch_scc1 A_y2_g
    s_sleep 2
    s_sub_u32 s57, s57, 1
    s_cmp_lg_u32 s57, 0
    s_cbranch_scc1 A_y2_w
A_y2_g:
    ds_read2st64_b32 v[124:125], v141 offset0:10 offset1:74
    ds_read2st64_b32 v[126:127], v141 offset0:138 offset1:202
    ds_read2st64_b32 v[128:129], v141 offset0:15 offset1:79
    ds_read2st64_b32 v[130:131], v141 offset0:143 offset1:207
    s_waitcnt lgkmcnt(2)
    v_fma_f32 v124, v124, v12, v56
    v_fma_f32 v125, v125, v13, v57
    v_fma_f32 v126, v126, v14, v58
    v_fma_f32 v127, v127, v15, v59
    v_cvt_pk_bf16_f32 v124, v124, v125
    v_cvt_pk_bf16_f32 v125, v126, v127
    buffer_store_dwordx2 v[124:125], v144, s[64:67], s10 offen
    s_waitcnt lgkmcnt(0)
    v_fma_f32 v128, v128, v16, v64
    v_fma_f32 v129, v129, v17, v65
    v_fma_f32 v130, v130, v18, v66
    v_fma_f32 v131, v131, v19, v67
    v_cvt_pk_bf16_f32 v128, v128, v129
    v_cvt_pk_bf16_f32 v129, v130, v131
    buffer_store_dwordx2 v[128:129], v145, s[64:67], s11 offen
    s_endpgm
A_retry:
    s_and_b64 s[48:49], s[58:59], s[12:13]
    s_cbranch_scc0 A_r0_ok
A_r0:
    buffer_load_dwordx4 v[4:7], v137, s[68:71], 0 offen sc1
    buffer_load_dwordx4 v[20:23], v139, s[68:71], 0 offen sc1
    buffer_load_dword v36, v138, s[68:71], 0 offen sc1
    s_sub_u32 s57, s57, 1
    s_cmp_eq_u32 s57, 0
    s_cbranch_scc1 A_ready
    s_waitcnt vmcnt(0)
    v_add_u32 v113, s39, v23
    v_dot2_u32_u16 v112, v4, s72, v113
    v_dot2_u32_u16 v112, v5, s73, v112
    v_dot2_u32_u16 v112, v6, s74, v112
    v_dot2_u32_u16 v112, v7, s75, v112
    s_nop 2
    v_alignbit_b32 v112, v112, v112, v136
    s_nop 1
    v_add_u32_dpp v112, v112, v112 quad_perm:[1,0,3,2] row_mask:0xf bank_mask:0xf
    s_nop 1
    v_add_u32_dpp v112, v112, v112 quad_perm:[2,3,0,1] row_mask:0xf bank_mask:0xf
    v_cmp_ne_u32 vcc, v112, v36
    s_nop 0
    s_and_b64 s[48:49], vcc, s[12:13]
    s_cbranch_scc1 A_r0
    v_lshlrev_b32 v114, 16, v22
    v_and_b32 v115, s56, v22
    v_pk_mul_f32 v[114:115], v[114:115], v[20:21] neg_lo:[1,0] neg_hi:[1,0]
    v_lshlrev_b32 v40, 16, v4
    v_and_b32 v41, s56, v4
    v_lshlrev_b32 v44, 16, v6
    v_and_b32 v45, s56, v6
    v_pk_fma_f32 v[72:73], v[40:41], v[20:21], v[114:115] op_sel:[0,0,0] op_sel_hi:[1,0,0]
    v_lshlrev_b32 v42, 16, v5
    v_and_b32 v43, s56, v5
    v_pk_fma_f32 v[76:77], v[44:45], v[20:21], v[114:115] op_sel:[0,1,1] op_sel_hi:[1,1,1]
    v_lshlrev_b32 v46, 16, v7
    v_and_b32 v47, s56, v7
    v_pk_fma_f32 v[74:75], v[42:43], v[20:21], v[114:115] op_sel:[0,0,0] op_sel_hi:[1,0,0]
    v_pk_fma_f32 v[78:79], v[46:47], v[20:21], v[114:115] op_sel:[0,1,1] op_sel_hi:[1,1,1]
    v_cvt_pk_bf16_f32 v104, v72, v76
    v_cvt_pk_bf16_f32 v105, v73, v77
    v_cvt_pk_bf16_f32 v106, v74, v78
    v_cvt_pk_bf16_f32 v107, v75, v79
    ds_write2st64_b32 v140, v104, v105 offset0:0 offset1:20
    ds_write2st64_b32 v140, v106, v107 offset0:40 offset1:60
A_r0_ok:
    s_and_b64 s[48:49], s[58:59], s[14:15]
    s_cbranch_scc0 A_r1_ok
A_r1:
    buffer_load_dwordx4 v[8:11], v137, s[68:71], s9 offen sc1
    buffer_load_dwordx4 v[24:27], v139, s[68:71], s5 offen sc1
    buffer_load_dword v36, v138, s[68:71], 0 offen sc1
    s_sub_u32 s57, s57, 1
    s_cmp_eq_u32 s57, 0
    s_cbranch_scc1 A_ready
    s_waitcnt vmcnt(0)
    v_add_u32 v113, s39, v27
    v_dot2_u32_u16 v112, v8, s72, v113
    v_dot2_u32_u16 v112, v9, s73, v112
    v_dot2_u32_u16 v112, v10, s74, v112
    v_dot2_u32_u16 v112, v11, s75, v112
    s_nop 2
    v_alignbit_b32 v112, v112, v112, v136
    s_nop 1
    v_add_u32_dpp v112, v112, v112 quad_perm:[1,0,3,2] row_mask:0xf bank_mask:0xf
    s_nop 1
    v_add_u32_dpp v112, v112, v112 quad_perm:[2,3,0,1] row_mask:0xf bank_mask:0xf
    v_cmp_ne_u32 vcc, v112, v36
    s_nop 0
    s_and_b64 s[48:49], vcc, s[14:15]
    s_cbranch_scc1 A_r1
    v_lshlrev_b32 v114, 16, v26
    v_and_b32 v115, s56, v26
    v_pk_mul_f32 v[114:115], v[114:115], v[24:25] neg_lo:[1,0] neg_hi:[1,0]
    v_lshlrev_b32 v48, 16, v8
    v_and_b32 v49, s56, v8
    v_lshlrev_b32 v52, 16, v10
    v_and_b32 v53, s56, v10
    v_pk_fma_f32 v[80:81], v[48:49], v[24:25], v[114:115] op_sel:[0,0,0] op_sel_hi:[1,0,0]
    v_lshlrev_b32 v50, 16, v9
    v_and_b32 v51, s56, v9
    v_pk_fma_f32 v[84:85], v[52:53], v[24:25], v[114:115] op_sel:[0,1,1] op_sel_hi:[1,1,1]
    v_lshlrev_b32 v54, 16, v11
    v_and_b32 v55, s56, v11
    v_pk_fma_f32 v[82:83], v[50:51], v[24:25], v[114:115] op_sel:[0,0,0] op_sel_hi:[1,0,0]
    v_pk_fma_f32 v[86:87], v[54:55], v[24:25], v[114:115] op_sel:[0,1,1] op_sel_hi:[1,1,1]
    v_cvt_pk_bf16_f32 v104, v80, v84
    v_cvt_pk_bf16_f32 v105, v81, v85
    v_cvt_pk_bf16_f32 v106, v82, v86
    v_cvt_pk_bf16_f32 v107, v83, v87
    ds_write2st64_b32 v140, v104, v105 offset0:4 offset1:24
    ds_write2st64_b32 v140, v106, v107 offset0:44 offset1:64
A_r1_ok:
    s_and_b64 s[48:49], s[58:59], s[16:17]
    s_cbranch_scc0 A_r2_ok
A_r2:
    buffer_load_dwordx4 v[12:15], v137, s[68:71], s10 offen sc1
    buffer_load_dwordx4 v[28:31], v139, s[68:71], s6 offen sc1
    buffer_load_dword v36, v138, s[68:71], 0 offen sc1
    s_sub_u32 s57, s57, 1
    s_cmp_eq_u32 s57, 0
    s_cbranch_scc1 A_ready
    s_waitcnt vmcnt(0)
    v_add_u32 v113, s39, v31
    v_dot2_u32_u16 v112, v12, s72, v113
    v_dot2_u32_u16 v112, v13, s73, v112
    v_dot2_u32_u16 v112, v14, s74, v112
    v_dot2_u32_u16 v112, v15, s75, v112
    s_nop 2
    v_alignbit_b32 v112, v112, v112, v136
    s_nop 1
    v_add_u32_dpp v112, v112, v112 quad_perm:[1,0,3,2] row_mask:0xf bank_mask:0xf
    s_nop 1
    v_add_u32_dpp v112, v112, v112 quad_perm:[2,3,0,1] row_mask:0xf bank_mask:0xf
    v_cmp_ne_u32 vcc, v112, v36
    s_nop 0
    s_and_b64 s[48:49], vcc, s[16:17]
    s_cbranch_scc1 A_r2
    v_lshlrev_b32 v114, 16, v30
    v_and_b32 v115, s56, v30
    v_pk_mul_f32 v[114:115], v[114:115], v[28:29] neg_lo:[1,0] neg_hi:[1,0]
    v_lshlrev_b32 v56, 16, v12
    v_and_b32 v57, s56, v12
    v_lshlrev_b32 v60, 16, v14
    v_and_b32 v61, s56, v14
    v_pk_fma_f32 v[88:89], v[56:57], v[28:29], v[114:115] op_sel:[0,0,0] op_sel_hi:[1,0,0]
    v_lshlrev_b32 v58, 16, v13
    v_and_b32 v59, s56, v13
    v_pk_fma_f32 v[92:93], v[60:61], v[28:29], v[114:115] op_sel:[0,1,1] op_sel_hi:[1,1,1]
    v_lshlrev_b32 v62, 16, v15
    v_and_b32 v63, s56, v15
    v_pk_fma_f32 v[90:91], v[58:59], v[28:29], v[114:115] op_sel:[0,0,0] op_sel_hi:[1,0,0]
    v_pk_fma_f32 v[94:95], v[62:63], v[28:29], v[114:115] op_sel:[0,1,1] op_sel_hi:[1,1,1]
    v_cvt_pk_bf16_f32 v104, v88, v92
    v_cvt_pk_bf16_f32 v105, v89, v93
    v_cvt_pk_bf16_f32 v106, v90, v94
    v_cvt_pk_bf16_f32 v107, v91, v95
    ds_write2st64_b32 v140, v104, v105 offset0:8 offset1:28
    ds_write2st64_b32 v140, v106, v107 offset0:48 offset1:68
A_r2_ok:
    s_and_b64 s[48:49], s[58:59], s[18:19]
    s_cbranch_scc0 A_r3_ok
A_r3:
    buffer_load_dwordx4 v[16:19], v137, s[68:71], s11 offen sc1
    buffer_load_dwordx4 v[32:35], v139, s[68:71], s7 offen sc1
    buffer_load_dword v36, v138, s[68:71], 0 offen sc1
    s_sub_u32 s57, s57, 1
    s_cmp_eq_u32 s57, 0
    s_cbranch_scc1 A_ready
    s_waitcnt vmcnt(0)
    v_add_u32 v113, s39, v35
    v_dot2_u32_u16 v112, v16, s72, v113
    v_dot2_u32_u16 v112, v17, s73, v112
    v_dot2_u32_u16 v112, v18, s74, v112
    v_dot2_u32_u16 v112, v19, s75, v112
    s_nop 2
    v_alignbit_b32 v112, v112, v112, v136
    s_nop 1
    v_add_u32_dpp v112, v112, v112 quad_perm:[1,0,3,2] row_mask:0xf bank_mask:0xf
    s_nop 1
    v_add_u32_dpp v112, v112, v112 quad_perm:[2,3,0,1] row_mask:0xf bank_mask:0xf
    v_cmp_ne_u32 vcc, v112, v36
    s_nop 0
    s_and_b64 s[48:49], vcc, s[18:19]
    s_cbranch_scc1 A_r3
    v_lshlrev_b32 v114, 16, v34
    v_and_b32 v115, s56, v34
    v_pk_mul_f32 v[114:115], v[114:115], v[32:33] neg_lo:[1,0] neg_hi:[1,0]
    v_lshlrev_b32 v64, 16, v16
    v_and_b32 v65, s56, v16
    v_lshlrev_b32 v68, 16, v18
    v_and_b32 v69, s56, v18
    v_pk_fma_f32 v[96:97], v[64:65], v[32:33], v[114:115] op_sel:[0,0,0] op_sel_hi:[1,0,0]
    v_lshlrev_b32 v66, 16, v17
    v_and_b32 v67, s56, v17
    v_pk_fma_f32 v[100:101], v[68:69], v[32:33], v[114:115] op_sel:[0,1,1] op_sel_hi:[1,1,1]
    v_lshlrev_b32 v70, 16, v19
    v_and_b32 v71, s56, v19
    v_pk_fma_f32 v[98:99], v[66:67], v[32:33], v[114:115] op_sel:[0,0,0] op_sel_hi:[1,0,0]
    v_pk_fma_f32 v[102:103], v[70:71], v[32:33], v[114:115] op_sel:[0,1,1] op_sel_hi:[1,1,1]
    v_cvt_pk_bf16_f32 v104, v96, v100
    v_cvt_pk_bf16_f32 v105, v97, v101
    v_cvt_pk_bf16_f32 v106, v98, v102
    v_cvt_pk_bf16_f32 v107, v99, v103
    ds_write2st64_b32 v140, v104, v105 offset0:12 offset1:32
    ds_write2st64_b32 v140, v106, v107 offset0:52 offset1:72
A_r3_ok:
    s_branch A_ready
L_code_end:
.fill 64, 4, 0xbf800000
.section .rodata,"a"
.p2align 6
.amdhsa_kernel recurrent_scan__ssm_conv_s4__moe_arch_mod__prompt_kernel
  .amdhsa_next_free_vgpr 168
  .amdhsa_next_free_sgpr 102
  .amdhsa_accum_offset 168
  .amdhsa_group_segment_fixed_size 0
  .amdhsa_kernarg_size 136
  .amdhsa_user_sgpr_count 2
  .amdhsa_user_sgpr_kernarg_segment_ptr 1
  .amdhsa_system_sgpr_workgroup_id_x 1
.end_amdhsa_kernel
```
